```python
import torch

def _softmax(x, axis=-1):
    return torch.softmax(x, dim=axis)
def _gelu(x):
    return torch.nn.functional.gelu(x, approximate="tanh")
def _silu(x):
    return torch.nn.functional.silu(x)
def _sigmoid(x):
    return torch.sigmoid(x)
def _layernorm(x, axis=-1, eps=1e-5):
    m = x.mean(dim=axis, keepdim=True)
    v = x.var(dim=axis, keepdim=True, unbiased=False)
    return (x - m) / torch.sqrt(v + eps)
def _scatter_add(tgt, idx, src, axis=0):
    return tgt.clone().index_add_(axis, idx, src)
def _segment_sum(src, seg, n):
    out = torch.zeros((n,) + src.shape[1:], dtype=src.dtype)
    return out.index_add_(0, seg, src)
def _pad(x, pw):
    flat = tuple(v for pair in reversed(pw) for v in pair)
    return torch.nn.functional.pad(x, flat)

kernel_name = 'standalone__paged_block_table_kv_radixattention__decode'

def setup_inputs():

    _w = (lambda a: (lambda t: t.to(torch.bfloat16) if t.is_floating_point() else t)(torch.as_tensor(a)))
    B, H, Hkv, Dh = 8, 32, 8, 128
    Lk = 8192
    bs = 16
    nb = max(2, Lk // bs)
    P = max(1, nb // 2)
    n_phys = P + B * (nb - P)
    shared = torch.arange(P, dtype=torch.int64)
    priv = P + torch.arange(B * (nb - P), dtype=torch.int64).reshape(B, nb - P)
    bt = torch.cat([torch.tile(shared[None, :], (B, 1)), priv], dim=1)
    ctx = nb * bs - (torch.arange(1, B + 1, dtype=torch.int64) * 2654435761) % max(1, (nb * bs - P * bs) // 2)
    return {
        "q": _w((lambda *s: torch.randn(*s, dtype=torch.bfloat16) * 0.8)(B, H, Dh)),
        "k_cache": _w((lambda *s: torch.randn(*s, dtype=torch.bfloat16) * 0.8)(n_phys, bs, Hkv, Dh)),
        "v_cache": _w((lambda *s: torch.randn(*s, dtype=torch.bfloat16) * 0.05)(n_phys, bs, Hkv, Dh)),
        "block_table": _w(bt.to(torch.int64)),
        "ctx_lens": _w(torch.as_tensor(ctx).to(torch.int64)),
    }

def reference(q, k_cache, v_cache, block_table, ctx_lens):
    B, H, Dh = q.shape
    n_phys, bs, Hkv, _ = k_cache.shape
    nb = block_table.shape[1]
    Lk = nb * bs
    rep = H // Hkv
    k = k_cache[block_table].reshape(B, Lk, Hkv, Dh)
    v = v_cache[block_table].reshape(B, Lk, Hkv, Dh)
    k = (lambda x, n, axis: torch.repeat_interleave(x, n, dim=axis))(k, rep, axis=2)
    v = (lambda x, n, axis: torch.repeat_interleave(x, n, dim=axis))(v, rep, axis=2)
    scores = torch.einsum("bhd,bkhd->bhk", q, k) * (Dh ** -0.5)
    pos = torch.arange(Lk)
    valid = pos[None, :] < ctx_lens[:, None]
    scores = torch.where(valid[:, None, :], scores, -1e9)
    p = _softmax(scores, axis=-1)
    return torch.einsum("bhk,bkhd->bhd", p, v)
```

```asm
; @launch kernel=standalone__paged_block_table_kv_radixattention__decode_kernel grid=(256,1,1) block=(512,1,1) lds=141312
; @launch kernel=combine_kernel grid=(256,1,1) block=(256,1,1) lds=0
.amdgcn_target "amdgcn-amd-amdhsa--gfx950"
.text
.globl standalone__paged_block_table_kv_radixattention__decode_kernel
.p2align 8
.type standalone__paged_block_table_kv_radixattention__decode_kernel,@function
standalone__paged_block_table_kv_radixattention__decode_kernel:
    s_cmp_ge_u32 s2, 256
    s_cbranch_scc1 L_end
    s_load_dwordx16 s[4:19], s[0:1], 0
    v_lshrrev_b32 v6, 6, v0
    v_and_b32 v1, 63, v0
    v_readfirstlane_b32 s89, v6
    v_lshrrev_b32 v2, 4, v1
    v_and_b32 v3, 15, v1
    s_mov_b32 s95, 0x80000000
    s_mov_b32 s23, 0x20000
    s_mov_b32 s22, 75497472
    s_mov_b32 s39, 0x20000
    s_mov_b32 s38, 16384
    v_lshlrev_b32 v0, 2, v2
    v_xor_b32 v0, v0, v3
    v_lshlrev_b32 v30, 11, v2
    s_lshl_b32 s96, s89, 14
    v_lshl_add_u32 v12, v0, 4, v30
    v_xor_b32 v13, 1, v0
    v_lshl_add_u32 v13, v13, 4, v30
    v_xor_b32 v14, 2, v0
    v_lshl_add_u32 v14, v14, 4, v30
    v_xor_b32 v15, 3, v0
    v_lshl_add_u32 v15, v15, 4, v30
    s_cmp_lt_u32 s2, 44
    s_cbranch_scc1 L_S
    s_mov_b32 s68, 0x10bd782c
    s_cmp_ge_u32 s2, 74
    s_cselect_b32 s68, 0x213e694a, s68
    s_cmp_ge_u32 s2, 100
    s_cselect_b32 s68, 0x323a6264, s68
    s_cmp_ge_u32 s2, 124
    s_cselect_b32 s68, 0xbb537c, s68
    s_cmp_ge_u32 s2, 144
    s_cselect_b32 s68, 0x14ba8c90, s68
    s_cmp_ge_u32 s2, 178
    s_cselect_b32 s68, 0x213b7db2, s68
    s_cmp_ge_u32 s2, 208
    s_cselect_b32 s68, 0x363b6ed0, s68
    s_cmp_ge_u32 s2, 234
    s_cselect_b32 s68, 0x53c5fea, s68
    s_and_b32 s70, s68, 255
    s_sub_u32 s70, s2, s70
    s_bfe_u32 s84, s68, 0x30008
    s_bfe_u32 s72, s68, 0x5000b
    s_bfe_u32 s69, s68, 0x70010
    s_bfe_u32 s73, s68, 0x50017
    s_cmp_ge_u32 s70, s72
    s_cselect_b32 s0, 4, 0
    s_cselect_b32 s75, s72, 0
    s_sub_u32 s70, s70, s75
    s_and_b32 s75, s89, 3
    s_add_u32 s0, s0, s75
    s_mul_i32 s71, s70, s69
    s_min_u32 s75, s70, s73
    s_cselect_b32 s76, 1, 0
    s_add_u32 s71, s71, s75
    s_add_u32 s71, s71, 1024
    s_add_u32 s76, s76, s69
    s_add_u32 s75, s71, s76
    s_add_u32 s76, s71, s75
    s_add_u32 s76, s76, 1
    s_lshr_b32 s76, s76, 1
    s_lshl_b32 s1, s71, 2
    s_cmp_ge_u32 s89, 4
    s_cselect_b32 s71, s76, s71
    s_cselect_b32 s75, s75, s76
    s_lshl_b32 s86, s71, 2
    s_lshl_b32 s97, s75, 2
    s_lshr_b32 s75, s89, 2
    s_add_u32 s75, s75, s70
    s_lshr_b32 s68, s68, 28
    s_cmp_eq_u32 s75, s72
    s_cselect_b32 s68, s68, 0
    s_sub_u32 s88, s97, s86
    s_sub_u32 s88, s88, s68
    s_mov_b32 s85, s70
    s_mov_b32 s50, 0
L_P_job:
    s_lshl_b32 s91, s84, 12
    s_add_u32 s91, s91, s86
    s_lshl_b32 s91, s91, 3
    s_add_u32 s91, s91, s0
    s_lshl_b32 s40, s91, 8
    v_sub_u32 v4, s88, v2
    s_lshl_b32 s90, s84, 11
    s_lshr_b32 s91, s86, 4
    s_lshl_b32 s91, s91, 2
    s_add_u32 s90, s90, s91
    s_add_u32 s91, s90, 32
    s_lshl_b32 s49, s84, 2
    s_waitcnt lgkmcnt(0)
    s_mov_b32 s36, s10
    s_mov_b32 s37, s11
    s_mov_b32 s20, s6
    s_mov_b32 s21, s7
    s_buffer_load_dwordx8 s[68:75], s[36:39], s90
    s_buffer_load_dword s76, s[36:39], s91
    s_load_dword s3, s[12:13], s49
    s_add_u32 s52, s40, 0
    s_add_u32 m0, s96, 0
    v_subrev_u32 v6, 1, v4
    v_and_or_b32 v6, v6, s95, v12
    buffer_load_dwordx4 v6, s[20:23], s52 offen sc0 sc1 nt lds
    s_add_u32 s53, s40, 8192
    s_add_u32 m0, s96, 1024
    v_subrev_u32 v7, 5, v4
    v_and_or_b32 v7, v7, s95, v13
    buffer_load_dwordx4 v7, s[20:23], s53 offen sc0 sc1 nt lds
    s_add_u32 s54, s40, 16384
    s_add_u32 m0, s96, 2048
    v_subrev_u32 v6, 9, v4
    v_and_or_b32 v6, v6, s95, v14
    buffer_load_dwordx4 v6, s[20:23], s54 offen sc0 sc1 nt lds
    s_add_u32 s55, s40, 24576
    s_add_u32 m0, s96, 3072
    v_subrev_u32 v7, 13, v4
    v_and_or_b32 v7, v7, s95, v15
    buffer_load_dwordx4 v7, s[20:23], s55 offen sc0 sc1 nt lds
    s_mov_b32 s28, s4
    s_mov_b32 s29, s5
    s_mov_b32 s31, 0x20000
    s_mov_b32 s30, 65536
    s_lshl_b32 s77, s84, 13
    s_lshl_b32 s78, s0, 10
    s_add_u32 s77, s77, s78
    v_lshlrev_b32 v5, 8, v2
    v_lshl_add_u32 v5, v0, 4, v5
    s_lshl_b32 s78, s89, 10
    s_add_u32 m0, s78, 133120
    s_nop 0
    buffer_load_dwordx4 v5, s[28:31], s77 offen lds
    s_add_u32 s56, s40, 32768
    s_add_u32 m0, s96, 4096
    v_subrev_u32 v6, 17, v4
    v_and_or_b32 v6, v6, s95, v12
    buffer_load_dwordx4 v6, s[20:23], s56 offen sc0 sc1 nt lds
    s_add_u32 s57, s40, 40960
    s_add_u32 m0, s96, 5120
    v_subrev_u32 v7, 21, v4
    v_and_or_b32 v7, v7, s95, v13
    buffer_load_dwordx4 v7, s[20:23], s57 offen sc0 sc1 nt lds
    s_add_u32 s58, s40, 49152
    s_add_u32 m0, s96, 6144
    v_subrev_u32 v6, 25, v4
    v_and_or_b32 v6, v6, s95, v14
    buffer_load_dwordx4 v6, s[20:23], s58 offen sc0 sc1 nt lds
    s_add_u32 s59, s40, 57344
    s_add_u32 m0, s96, 7168
    v_subrev_u32 v7, 29, v4
    v_and_or_b32 v7, v7, s95, v15
    buffer_load_dwordx4 v7, s[20:23], s59 offen sc0 sc1 nt lds
    s_add_u32 s60, s40, 65536
    s_add_u32 m0, s96, 8192
    v_subrev_u32 v6, 33, v4
    v_and_or_b32 v6, v6, s95, v12
    buffer_load_dwordx4 v6, s[20:23], s60 offen sc0 sc1 nt lds
    s_add_u32 s61, s40, 73728
    s_add_u32 m0, s96, 9216
    v_subrev_u32 v7, 37, v4
    v_and_or_b32 v7, v7, s95, v13
    buffer_load_dwordx4 v7, s[20:23], s61 offen sc0 sc1 nt lds
    s_add_u32 s62, s40, 81920
    s_add_u32 m0, s96, 10240
    v_subrev_u32 v6, 41, v4
    v_and_or_b32 v6, v6, s95, v14
    buffer_load_dwordx4 v6, s[20:23], s62 offen sc0 sc1 nt lds
    s_add_u32 s63, s40, 90112
    s_add_u32 m0, s96, 11264
    v_subrev_u32 v7, 45, v4
    v_and_or_b32 v7, v7, s95, v15
    buffer_load_dwordx4 v7, s[20:23], s63 offen sc0 sc1 nt lds
    s_add_u32 s64, s40, 98304
    s_add_u32 m0, s96, 12288
    v_subrev_u32 v6, 49, v4
    v_and_or_b32 v6, v6, s95, v12
    buffer_load_dwordx4 v6, s[20:23], s64 offen sc0 sc1 nt lds
    s_add_u32 s65, s40, 106496
    s_add_u32 m0, s96, 13312
    v_subrev_u32 v7, 53, v4
    v_and_or_b32 v7, v7, s95, v13
    buffer_load_dwordx4 v7, s[20:23], s65 offen sc0 sc1 nt lds
    s_add_u32 s66, s40, 114688
    s_add_u32 m0, s96, 14336
    v_subrev_u32 v6, 57, v4
    v_and_or_b32 v6, v6, s95, v14
    buffer_load_dwordx4 v6, s[20:23], s66 offen sc0 sc1 nt lds
    s_add_u32 s67, s40, 122880
    s_add_u32 m0, s96, 15360
    v_subrev_u32 v7, 61, v4
    v_and_or_b32 v7, v7, s95, v15
    buffer_load_dwordx4 v7, s[20:23], s67 offen sc0 sc1 nt lds
    v_and_b32 v24, 12, v3
    v_xor_b32 v25, v24, v2
    v_lshlrev_b32 v24, 6, v24
    v_add_u32 v24, s78, v24
    v_xor_b32 v20, 0, v25
    v_lshl_add_u32 v20, v20, 4, v24
    v_add_u32 v20, 133120, v20
    v_xor_b32 v21, 4, v25
    v_lshl_add_u32 v21, v21, 4, v24
    v_add_u32 v21, 133120, v21
    v_xor_b32 v22, 8, v25
    v_lshl_add_u32 v22, v22, 4, v24
    v_add_u32 v22, 133120, v22
    v_xor_b32 v23, 12, v25
    v_lshl_add_u32 v23, v23, 4, v24
    v_add_u32 v23, 133120, v23
    v_lshl_add_u32 v8, v3, 4, v30
    s_mov_b32 s92, 0x3e0293ee
    s_mov_b32 s93, 0x05040100
    s_mov_b32 s94, 0x07060302
    v_and_b32 v6, 3, v3
    v_lshrrev_b32 v7, 2, v3
    v_lshl_add_u32 v6, v6, 2, v7
    v_lshlrev_b32 v6, 8, v6
    v_add_u32 v6, s96, v6
    v_xor_b32 v7, v2, v3
    v_xor_b32 v16, 0, v7
    v_lshl_add_u32 v16, v16, 4, v6
    v_xor_b32 v17, 4, v7
    v_lshl_add_u32 v17, v17, 4, v6
    v_xor_b32 v18, 8, v7
    v_lshl_add_u32 v18, v18, 4, v6
    v_xor_b32 v19, 12, v7
    v_lshl_add_u32 v19, v19, 4, v6
    s_mov_b32 s24, s8
    s_mov_b32 s25, s9
    s_mov_b32 s26, 75497472
    s_mov_b32 s27, 0x20000
    s_mov_b32 s32, s18
    s_mov_b32 s33, s19
    s_mov_b32 s34, 301989888
    s_mov_b32 s35, 0x20000
    s_mov_b32 s49, 0
    s_waitcnt lgkmcnt(0)
    s_bfe_u32 s87, s86, 0x20002
    s_lshl_b32 s90, s0, 8
    s_lshr_b32 s91, s40, 15
    s_cmp_lg_u32 s68, s91
    s_cselect_b32 s49, 1, s49
    s_add_u32 s91, s91, 1
    s_cmp_lg_u32 s69, s91
    s_cselect_b32 s49, 1, s49
    s_add_u32 s91, s91, 1
    s_cmp_lg_u32 s70, s91
    s_cselect_b32 s49, 1, s49
    s_add_u32 s91, s91, 1
    s_cmp_lg_u32 s71, s91
    s_cselect_b32 s49, 1, s49
    s_add_u32 s91, s91, 1
    s_cmp_lg_u32 s72, s91
    s_cselect_b32 s49, 1, s49
    s_lshl_b32 s40, s68, 15
    s_add_u32 s40, s40, s90
    s_lshl_b32 s41, s69, 15
    s_add_u32 s41, s41, s90
    s_lshl_b32 s42, s70, 15
    s_add_u32 s42, s42, s90
    s_lshl_b32 s43, s71, 15
    s_add_u32 s43, s43, s90
    s_lshl_b32 s44, s72, 15
    s_add_u32 s44, s44, s90
    s_lshl_b32 s45, s73, 15
    s_add_u32 s45, s45, s90
    s_lshl_b32 s46, s74, 15
    s_add_u32 s46, s46, s90
    s_lshl_b32 s47, s75, 15
    s_add_u32 s47, s47, s90
    s_lshl_b32 s48, s76, 15
    s_add_u32 s48, s48, s90
    s_sub_u32 s90, s3, 1
    s_min_u32 s90, s90, 8191
    s_add_u32 s90, s90, 1
    s_cmp_le_u32 s90, s1
    s_cbranch_scc1 L_P_next
    s_min_u32 s90, s90, s97
    s_sub_i32 s90, s90, s86
    s_cmp_lg_u32 s90, s88
    s_cselect_b32 s49, 1, s49
    s_mov_b32 s88, s90
    s_cmp_eq_u32 s49, 0
    s_cbranch_scc1 L_P_ok
    s_waitcnt vmcnt(0)
    s_add_u32 s90, s87, 0
    s_and_b32 s91, s90, 3
    s_lshl_b32 s91, s91, 13
    s_cmp_ge_u32 s90, 4
    s_cselect_b32 s52, s41, s40
    s_cselect_b32 s56, s42, s41
    s_cselect_b32 s60, s43, s42
    s_cselect_b32 s64, s44, s43
    s_add_u32 s52, s52, s91
    s_add_u32 s56, s56, s91
    s_add_u32 s60, s60, s91
    s_add_u32 s64, s64, s91
    s_add_u32 s90, s87, 1
    s_and_b32 s91, s90, 3
    s_lshl_b32 s91, s91, 13
    s_cmp_ge_u32 s90, 4
    s_cselect_b32 s53, s41, s40
    s_cselect_b32 s57, s42, s41
    s_cselect_b32 s61, s43, s42
    s_cselect_b32 s65, s44, s43
    s_add_u32 s53, s53, s91
    s_add_u32 s57, s57, s91
    s_add_u32 s61, s61, s91
    s_add_u32 s65, s65, s91
    s_add_u32 s90, s87, 2
    s_and_b32 s91, s90, 3
    s_lshl_b32 s91, s91, 13
    s_cmp_ge_u32 s90, 4
    s_cselect_b32 s54, s41, s40
    s_cselect_b32 s58, s42, s41
    s_cselect_b32 s62, s43, s42
    s_cselect_b32 s66, s44, s43
    s_add_u32 s54, s54, s91
    s_add_u32 s58, s58, s91
    s_add_u32 s62, s62, s91
    s_add_u32 s66, s66, s91
    s_add_u32 s90, s87, 3
    s_and_b32 s91, s90, 3
    s_lshl_b32 s91, s91, 13
    s_cmp_ge_u32 s90, 4
    s_cselect_b32 s55, s41, s40
    s_cselect_b32 s59, s42, s41
    s_cselect_b32 s63, s43, s42
    s_cselect_b32 s67, s44, s43
    s_add_u32 s55, s55, s91
    s_add_u32 s59, s59, s91
    s_add_u32 s63, s63, s91
    s_add_u32 s67, s67, s91
    v_sub_u32 v4, s88, v2
    s_add_u32 m0, s96, 0
    v_subrev_u32 v6, 1, v4
    v_and_or_b32 v6, v6, s95, v12
    buffer_load_dwordx4 v6, s[20:23], s52 offen sc0 sc1 nt lds
    s_add_u32 m0, s96, 1024
    v_subrev_u32 v7, 5, v4
    v_and_or_b32 v7, v7, s95, v13
    buffer_load_dwordx4 v7, s[20:23], s53 offen sc0 sc1 nt lds
    s_add_u32 m0, s96, 2048
    v_subrev_u32 v6, 9, v4
    v_and_or_b32 v6, v6, s95, v14
    buffer_load_dwordx4 v6, s[20:23], s54 offen sc0 sc1 nt lds
    s_add_u32 m0, s96, 3072
    v_subrev_u32 v7, 13, v4
    v_and_or_b32 v7, v7, s95, v15
    buffer_load_dwordx4 v7, s[20:23], s55 offen sc0 sc1 nt lds
    s_add_u32 m0, s96, 4096
    v_subrev_u32 v6, 17, v4
    v_and_or_b32 v6, v6, s95, v12
    buffer_load_dwordx4 v6, s[20:23], s56 offen sc0 sc1 nt lds
    s_add_u32 m0, s96, 5120
    v_subrev_u32 v7, 21, v4
    v_and_or_b32 v7, v7, s95, v13
    buffer_load_dwordx4 v7, s[20:23], s57 offen sc0 sc1 nt lds
    s_add_u32 m0, s96, 6144
    v_subrev_u32 v6, 25, v4
    v_and_or_b32 v6, v6, s95, v14
    buffer_load_dwordx4 v6, s[20:23], s58 offen sc0 sc1 nt lds
    s_add_u32 m0, s96, 7168
    v_subrev_u32 v7, 29, v4
    v_and_or_b32 v7, v7, s95, v15
    buffer_load_dwordx4 v7, s[20:23], s59 offen sc0 sc1 nt lds
    s_add_u32 m0, s96, 8192
    v_subrev_u32 v6, 33, v4
    v_and_or_b32 v6, v6, s95, v12
    buffer_load_dwordx4 v6, s[20:23], s60 offen sc0 sc1 nt lds
    s_add_u32 m0, s96, 9216
    v_subrev_u32 v7, 37, v4
    v_and_or_b32 v7, v7, s95, v13
    buffer_load_dwordx4 v7, s[20:23], s61 offen sc0 sc1 nt lds
    s_add_u32 m0, s96, 10240
    v_subrev_u32 v6, 41, v4
    v_and_or_b32 v6, v6, s95, v14
    buffer_load_dwordx4 v6, s[20:23], s62 offen sc0 sc1 nt lds
    s_add_u32 m0, s96, 11264
    v_subrev_u32 v7, 45, v4
    v_and_or_b32 v7, v7, s95, v15
    buffer_load_dwordx4 v7, s[20:23], s63 offen sc0 sc1 nt lds
    s_add_u32 m0, s96, 12288
    v_subrev_u32 v6, 49, v4
    v_and_or_b32 v6, v6, s95, v12
    buffer_load_dwordx4 v6, s[20:23], s64 offen sc0 sc1 nt lds
    s_add_u32 m0, s96, 13312
    v_subrev_u32 v7, 53, v4
    v_and_or_b32 v7, v7, s95, v13
    buffer_load_dwordx4 v7, s[20:23], s65 offen sc0 sc1 nt lds
    s_add_u32 m0, s96, 14336
    v_subrev_u32 v6, 57, v4
    v_and_or_b32 v6, v6, s95, v14
    buffer_load_dwordx4 v6, s[20:23], s66 offen sc0 sc1 nt lds
    s_add_u32 m0, s96, 15360
    v_subrev_u32 v7, 61, v4
    v_and_or_b32 v7, v7, s95, v15
    buffer_load_dwordx4 v7, s[20:23], s67 offen sc0 sc1 nt lds
    s_waitcnt vmcnt(0)
L_P_ok:
    s_add_u32 s90, s87, 0
    s_and_b32 s91, s90, 3
    s_lshl_b32 s91, s91, 13
    s_cmp_ge_u32 s90, 4
    s_cselect_b32 s68, s45, s44
    s_cselect_b32 s72, s46, s45
    s_cselect_b32 s76, s47, s46
    s_cselect_b32 s80, s48, s47
    s_add_u32 s68, s68, s91
    s_add_u32 s72, s72, s91
    s_add_u32 s76, s76, s91
    s_add_u32 s80, s80, s91
    s_add_u32 s90, s87, 1
    s_and_b32 s91, s90, 3
    s_lshl_b32 s91, s91, 13
    s_cmp_ge_u32 s90, 4
    s_cselect_b32 s69, s45, s44
    s_cselect_b32 s73, s46, s45
    s_cselect_b32 s77, s47, s46
    s_cselect_b32 s81, s48, s47
    s_add_u32 s69, s69, s91
    s_add_u32 s73, s73, s91
    s_add_u32 s77, s77, s91
    s_add_u32 s81, s81, s91
    s_add_u32 s90, s87, 2
    s_and_b32 s91, s90, 3
    s_lshl_b32 s91, s91, 13
    s_cmp_ge_u32 s90, 4
    s_cselect_b32 s70, s45, s44
    s_cselect_b32 s74, s46, s45
    s_cselect_b32 s78, s47, s46
    s_cselect_b32 s82, s48, s47
    s_add_u32 s70, s70, s91
    s_add_u32 s74, s74, s91
    s_add_u32 s78, s78, s91
    s_add_u32 s82, s82, s91
    s_add_u32 s90, s87, 3
    s_and_b32 s91, s90, 3
    s_lshl_b32 s91, s91, 13
    s_cmp_ge_u32 s90, 4
    s_cselect_b32 s71, s45, s44
    s_cselect_b32 s75, s46, s45
    s_cselect_b32 s79, s47, s46
    s_cselect_b32 s83, s48, s47
    s_add_u32 s71, s71, s91
    s_add_u32 s75, s75, s91
    s_add_u32 s79, s79, s91
    s_add_u32 s83, s83, s91
    v_subrev_u32 v48, 1, v4
    v_ashrrev_i32 v48, 31, v48
    v_and_b32 v48, 0xf149f2ca, v48
    v_subrev_u32 v49, 5, v4
    v_ashrrev_i32 v49, 31, v49
    v_and_b32 v49, 0xf149f2ca, v49
    v_subrev_u32 v50, 9, v4
    v_ashrrev_i32 v50, 31, v50
    v_and_b32 v50, 0xf149f2ca, v50
    v_subrev_u32 v51, 13, v4
    v_ashrrev_i32 v51, 31, v51
    v_and_b32 v51, 0xf149f2ca, v51
    v_subrev_u32 v52, 17, v4
    v_ashrrev_i32 v52, 31, v52
    v_and_b32 v52, 0xf149f2ca, v52
    v_subrev_u32 v53, 21, v4
    v_ashrrev_i32 v53, 31, v53
    v_and_b32 v53, 0xf149f2ca, v53
    v_subrev_u32 v54, 25, v4
    v_ashrrev_i32 v54, 31, v54
    v_and_b32 v54, 0xf149f2ca, v54
    v_subrev_u32 v55, 29, v4
    v_ashrrev_i32 v55, 31, v55
    v_and_b32 v55, 0xf149f2ca, v55
    v_subrev_u32 v56, 33, v4
    v_ashrrev_i32 v56, 31, v56
    v_and_b32 v56, 0xf149f2ca, v56
    v_subrev_u32 v57, 37, v4
    v_ashrrev_i32 v57, 31, v57
    v_and_b32 v57, 0xf149f2ca, v57
    v_subrev_u32 v58, 41, v4
    v_ashrrev_i32 v58, 31, v58
    v_and_b32 v58, 0xf149f2ca, v58
    v_subrev_u32 v59, 45, v4
    v_ashrrev_i32 v59, 31, v59
    v_and_b32 v59, 0xf149f2ca, v59
    v_subrev_u32 v60, 49, v4
    v_ashrrev_i32 v60, 31, v60
    v_and_b32 v60, 0xf149f2ca, v60
    v_subrev_u32 v61, 53, v4
    v_ashrrev_i32 v61, 31, v61
    v_and_b32 v61, 0xf149f2ca, v61
    v_subrev_u32 v62, 57, v4
    v_ashrrev_i32 v62, 31, v62
    v_and_b32 v62, 0xf149f2ca, v62
    v_subrev_u32 v63, 61, v4
    v_ashrrev_i32 v63, 31, v63
    v_and_b32 v63, 0xf149f2ca, v63
    v_subrev_u32 v64, 65, v4
    v_ashrrev_i32 v64, 31, v64
    v_and_b32 v64, 0xf149f2ca, v64
    v_subrev_u32 v65, 69, v4
    v_ashrrev_i32 v65, 31, v65
    v_and_b32 v65, 0xf149f2ca, v65
    v_subrev_u32 v66, 73, v4
    v_ashrrev_i32 v66, 31, v66
    v_and_b32 v66, 0xf149f2ca, v66
    v_subrev_u32 v67, 77, v4
    v_ashrrev_i32 v67, 31, v67
    v_and_b32 v67, 0xf149f2ca, v67
    v_subrev_u32 v68, 81, v4
    v_ashrrev_i32 v68, 31, v68
    v_and_b32 v68, 0xf149f2ca, v68
    v_subrev_u32 v69, 85, v4
    v_ashrrev_i32 v69, 31, v69
    v_and_b32 v69, 0xf149f2ca, v69
    v_subrev_u32 v70, 89, v4
    v_ashrrev_i32 v70, 31, v70
    v_and_b32 v70, 0xf149f2ca, v70
    v_subrev_u32 v71, 93, v4
    v_ashrrev_i32 v71, 31, v71
    v_and_b32 v71, 0xf149f2ca, v71
    v_subrev_u32 v72, 97, v4
    v_ashrrev_i32 v72, 31, v72
    v_and_b32 v72, 0xf149f2ca, v72
    v_subrev_u32 v73, 101, v4
    v_ashrrev_i32 v73, 31, v73
    v_and_b32 v73, 0xf149f2ca, v73
    v_subrev_u32 v74, 105, v4
    v_ashrrev_i32 v74, 31, v74
    v_and_b32 v74, 0xf149f2ca, v74
    v_subrev_u32 v75, 109, v4
    v_ashrrev_i32 v75, 31, v75
    v_and_b32 v75, 0xf149f2ca, v75
    v_subrev_u32 v76, 113, v4
    v_ashrrev_i32 v76, 31, v76
    v_and_b32 v76, 0xf149f2ca, v76
    v_subrev_u32 v77, 117, v4
    v_ashrrev_i32 v77, 31, v77
    v_and_b32 v77, 0xf149f2ca, v77
    v_subrev_u32 v78, 121, v4
    v_ashrrev_i32 v78, 31, v78
    v_and_b32 v78, 0xf149f2ca, v78
    v_subrev_u32 v79, 125, v4
    v_ashrrev_i32 v79, 31, v79
    v_and_b32 v79, 0xf149f2ca, v79
    s_waitcnt vmcnt(12)
    ds_read_b128 v[32:35], v20
    ds_read_b128 v[36:39], v21
    ds_read_b128 v[40:43], v22
    ds_read_b128 v[44:47], v23
    s_cmp_gt_i32 s3, 0
    s_cbranch_scc1 L_P_qok
    s_waitcnt lgkmcnt(0)
    v_mov_b32 v32, 0
    v_mov_b32 v33, 0
    v_mov_b32 v34, 0
    v_mov_b32 v35, 0
    v_mov_b32 v36, 0
    v_mov_b32 v37, 0
    v_mov_b32 v38, 0
    v_mov_b32 v39, 0
    v_mov_b32 v40, 0
    v_mov_b32 v41, 0
    v_mov_b32 v42, 0
    v_mov_b32 v43, 0
    v_mov_b32 v44, 0
    v_mov_b32 v45, 0
    v_mov_b32 v46, 0
    v_mov_b32 v47, 0
    s_nop 1
L_P_qok:
    ds_read_b128 v[80:83], v16 offset:0
    ds_read_b128 v[84:87], v17 offset:0
    ds_read_b128 v[88:91], v18 offset:0
    ds_read_b128 v[92:95], v19 offset:0
    s_waitcnt lgkmcnt(0)
    s_add_u32 m0, s96, 0
    v_subrev_u32 v6, 65, v4
    v_and_or_b32 v6, v6, s95, v12
    buffer_load_dwordx4 v6, s[20:23], s68 offen sc0 sc1 nt lds
    s_add_u32 m0, s96, 1024
    v_subrev_u32 v7, 69, v4
    v_and_or_b32 v7, v7, s95, v13
    buffer_load_dwordx4 v7, s[20:23], s69 offen sc0 sc1 nt lds
    s_add_u32 m0, s96, 2048
    v_subrev_u32 v6, 73, v4
    v_and_or_b32 v6, v6, s95, v14
    buffer_load_dwordx4 v6, s[20:23], s70 offen sc0 sc1 nt lds
    s_add_u32 m0, s96, 3072
    v_subrev_u32 v7, 77, v4
    v_and_or_b32 v7, v7, s95, v15
    buffer_load_dwordx4 v7, s[20:23], s71 offen sc0 sc1 nt lds
    v_mfma_f32_16x16x32_bf16 v[48:51], v[80:83], v[32:35], v[48:51]
    v_mfma_f32_16x16x32_bf16 v[48:51], v[84:87], v[36:39], v[48:51]
    v_mfma_f32_16x16x32_bf16 v[48:51], v[88:91], v[40:43], v[48:51]
    v_mfma_f32_16x16x32_bf16 v[48:51], v[92:95], v[44:47], v[48:51]
    s_waitcnt vmcnt(12)
    ds_read_b128 v[96:99], v16 offset:4096
    ds_read_b128 v[100:103], v17 offset:4096
    ds_read_b128 v[104:107], v18 offset:4096
    ds_read_b128 v[108:111], v19 offset:4096
    s_waitcnt lgkmcnt(0)
    s_add_u32 m0, s96, 4096
    v_subrev_u32 v6, 81, v4
    v_and_or_b32 v6, v6, s95, v12
    buffer_load_dwordx4 v6, s[20:23], s72 offen sc0 sc1 nt lds
    s_add_u32 m0, s96, 5120
    v_subrev_u32 v7, 85, v4
    v_and_or_b32 v7, v7, s95, v13
    buffer_load_dwordx4 v7, s[20:23], s73 offen sc0 sc1 nt lds
    s_add_u32 m0, s96, 6144
    v_subrev_u32 v6, 89, v4
    v_and_or_b32 v6, v6, s95, v14
    buffer_load_dwordx4 v6, s[20:23], s74 offen sc0 sc1 nt lds
    s_add_u32 m0, s96, 7168
    v_subrev_u32 v7, 93, v4
    v_and_or_b32 v7, v7, s95, v15
    buffer_load_dwordx4 v7, s[20:23], s75 offen sc0 sc1 nt lds
    v_mfma_f32_16x16x32_bf16 v[52:55], v[96:99], v[32:35], v[52:55]
    v_mfma_f32_16x16x32_bf16 v[52:55], v[100:103], v[36:39], v[52:55]
    v_mfma_f32_16x16x32_bf16 v[52:55], v[104:107], v[40:43], v[52:55]
    v_mfma_f32_16x16x32_bf16 v[52:55], v[108:111], v[44:47], v[52:55]
    s_waitcnt vmcnt(12)
    ds_read_b128 v[80:83], v16 offset:8192
    ds_read_b128 v[84:87], v17 offset:8192
    ds_read_b128 v[88:91], v18 offset:8192
    ds_read_b128 v[92:95], v19 offset:8192
    s_waitcnt lgkmcnt(0)
    s_add_u32 m0, s96, 8192
    v_subrev_u32 v6, 97, v4
    v_and_or_b32 v6, v6, s95, v12
    buffer_load_dwordx4 v6, s[20:23], s76 offen sc0 sc1 nt lds
    s_add_u32 m0, s96, 9216
    v_subrev_u32 v7, 101, v4
    v_and_or_b32 v7, v7, s95, v13
    buffer_load_dwordx4 v7, s[20:23], s77 offen sc0 sc1 nt lds
    s_add_u32 m0, s96, 10240
    v_subrev_u32 v6, 105, v4
    v_and_or_b32 v6, v6, s95, v14
    buffer_load_dwordx4 v6, s[20:23], s78 offen sc0 sc1 nt lds
    s_add_u32 m0, s96, 11264
    v_subrev_u32 v7, 109, v4
    v_and_or_b32 v7, v7, s95, v15
    buffer_load_dwordx4 v7, s[20:23], s79 offen sc0 sc1 nt lds
    v_mfma_f32_16x16x32_bf16 v[56:59], v[80:83], v[32:35], v[56:59]
    v_mfma_f32_16x16x32_bf16 v[56:59], v[84:87], v[36:39], v[56:59]
    v_mfma_f32_16x16x32_bf16 v[56:59], v[88:91], v[40:43], v[56:59]
    v_mfma_f32_16x16x32_bf16 v[56:59], v[92:95], v[44:47], v[56:59]
    s_waitcnt vmcnt(12)
    ds_read_b128 v[96:99], v16 offset:12288
    ds_read_b128 v[100:103], v17 offset:12288
    ds_read_b128 v[104:107], v18 offset:12288
    ds_read_b128 v[108:111], v19 offset:12288
    s_waitcnt lgkmcnt(0)
    s_add_u32 m0, s96, 12288
    v_subrev_u32 v6, 113, v4
    v_and_or_b32 v6, v6, s95, v12
    buffer_load_dwordx4 v6, s[20:23], s80 offen sc0 sc1 nt lds
    s_add_u32 m0, s96, 13312
    v_subrev_u32 v7, 117, v4
    v_and_or_b32 v7, v7, s95, v13
    buffer_load_dwordx4 v7, s[20:23], s81 offen sc0 sc1 nt lds
    s_add_u32 m0, s96, 14336
    v_subrev_u32 v6, 121, v4
    v_and_or_b32 v6, v6, s95, v14
    buffer_load_dwordx4 v6, s[20:23], s82 offen sc0 sc1 nt lds
    s_add_u32 m0, s96, 15360
    v_subrev_u32 v7, 125, v4
    v_and_or_b32 v7, v7, s95, v15
    buffer_load_dwordx4 v7, s[20:23], s83 offen sc0 sc1 nt lds
    v_mfma_f32_16x16x32_bf16 v[60:63], v[96:99], v[32:35], v[60:63]
    v_mfma_f32_16x16x32_bf16 v[60:63], v[100:103], v[36:39], v[60:63]
    v_mfma_f32_16x16x32_bf16 v[60:63], v[104:107], v[40:43], v[60:63]
    v_mfma_f32_16x16x32_bf16 v[60:63], v[108:111], v[44:47], v[60:63]
    s_waitcnt vmcnt(12)
    ds_read_b128 v[80:83], v16 offset:0
    ds_read_b128 v[84:87], v17 offset:0
    ds_read_b128 v[88:91], v18 offset:0
    ds_read_b128 v[92:95], v19 offset:0
    v_subrev_u32 v6, 1, v4
    v_and_or_b32 v6, v6, s95, v8
    buffer_load_dwordx4 v[128:131], v6, s[24:27], s52 offen sc0 sc1 nt
    v_subrev_u32 v7, 5, v4
    v_and_or_b32 v7, v7, s95, v8
    buffer_load_dwordx4 v[132:135], v7, s[24:27], s53 offen sc0 sc1 nt
    v_subrev_u32 v6, 9, v4
    v_and_or_b32 v6, v6, s95, v8
    buffer_load_dwordx4 v[136:139], v6, s[24:27], s54 offen sc0 sc1 nt
    v_subrev_u32 v7, 13, v4
    v_and_or_b32 v7, v7, s95, v8
    buffer_load_dwordx4 v[140:143], v7, s[24:27], s55 offen sc0 sc1 nt
    s_waitcnt lgkmcnt(0)
    v_mfma_f32_16x16x32_bf16 v[64:67], v[80:83], v[32:35], v[64:67]
    v_mfma_f32_16x16x32_bf16 v[64:67], v[84:87], v[36:39], v[64:67]
    v_mfma_f32_16x16x32_bf16 v[64:67], v[88:91], v[40:43], v[64:67]
    v_mfma_f32_16x16x32_bf16 v[64:67], v[92:95], v[44:47], v[64:67]
    s_waitcnt vmcnt(12)
    ds_read_b128 v[96:99], v16 offset:4096
    ds_read_b128 v[100:103], v17 offset:4096
    ds_read_b128 v[104:107], v18 offset:4096
    ds_read_b128 v[108:111], v19 offset:4096
    v_subrev_u32 v6, 17, v4
    v_and_or_b32 v6, v6, s95, v8
    buffer_load_dwordx4 v[144:147], v6, s[24:27], s56 offen sc0 sc1 nt
    v_subrev_u32 v7, 21, v4
    v_and_or_b32 v7, v7, s95, v8
    buffer_load_dwordx4 v[148:151], v7, s[24:27], s57 offen sc0 sc1 nt
    v_subrev_u32 v6, 25, v4
    v_and_or_b32 v6, v6, s95, v8
    buffer_load_dwordx4 v[152:155], v6, s[24:27], s58 offen sc0 sc1 nt
    v_subrev_u32 v7, 29, v4
    v_and_or_b32 v7, v7, s95, v8
    buffer_load_dwordx4 v[156:159], v7, s[24:27], s59 offen sc0 sc1 nt
    s_waitcnt lgkmcnt(0)
    v_mfma_f32_16x16x32_bf16 v[68:71], v[96:99], v[32:35], v[68:71]
    v_mfma_f32_16x16x32_bf16 v[68:71], v[100:103], v[36:39], v[68:71]
    v_mfma_f32_16x16x32_bf16 v[68:71], v[104:107], v[40:43], v[68:71]
    v_mfma_f32_16x16x32_bf16 v[68:71], v[108:111], v[44:47], v[68:71]
    s_waitcnt vmcnt(12)
    ds_read_b128 v[80:83], v16 offset:8192
    ds_read_b128 v[84:87], v17 offset:8192
    ds_read_b128 v[88:91], v18 offset:8192
    ds_read_b128 v[92:95], v19 offset:8192
    v_subrev_u32 v6, 33, v4
    v_and_or_b32 v6, v6, s95, v8
    buffer_load_dwordx4 v[160:163], v6, s[24:27], s60 offen sc0 sc1 nt
    v_subrev_u32 v7, 37, v4
    v_and_or_b32 v7, v7, s95, v8
    buffer_load_dwordx4 v[164:167], v7, s[24:27], s61 offen sc0 sc1 nt
    v_subrev_u32 v6, 41, v4
    v_and_or_b32 v6, v6, s95, v8
    buffer_load_dwordx4 v[168:171], v6, s[24:27], s62 offen sc0 sc1 nt
    v_subrev_u32 v7, 45, v4
    v_and_or_b32 v7, v7, s95, v8
    buffer_load_dwordx4 v[172:175], v7, s[24:27], s63 offen sc0 sc1 nt
    s_waitcnt lgkmcnt(0)
    v_mfma_f32_16x16x32_bf16 v[72:75], v[80:83], v[32:35], v[72:75]
    v_mfma_f32_16x16x32_bf16 v[72:75], v[84:87], v[36:39], v[72:75]
    v_mfma_f32_16x16x32_bf16 v[72:75], v[88:91], v[40:43], v[72:75]
    v_mfma_f32_16x16x32_bf16 v[72:75], v[92:95], v[44:47], v[72:75]
    s_waitcnt vmcnt(12)
    ds_read_b128 v[96:99], v16 offset:12288
    ds_read_b128 v[100:103], v17 offset:12288
    ds_read_b128 v[104:107], v18 offset:12288
    ds_read_b128 v[108:111], v19 offset:12288
    v_subrev_u32 v6, 49, v4
    v_and_or_b32 v6, v6, s95, v8
    buffer_load_dwordx4 v[176:179], v6, s[24:27], s64 offen sc0 sc1 nt
    v_subrev_u32 v7, 53, v4
    v_and_or_b32 v7, v7, s95, v8
    buffer_load_dwordx4 v[180:183], v7, s[24:27], s65 offen sc0 sc1 nt
    v_subrev_u32 v6, 57, v4
    v_and_or_b32 v6, v6, s95, v8
    buffer_load_dwordx4 v[184:187], v6, s[24:27], s66 offen sc0 sc1 nt
    v_subrev_u32 v7, 61, v4
    v_and_or_b32 v7, v7, s95, v8
    buffer_load_dwordx4 v[188:191], v7, s[24:27], s67 offen sc0 sc1 nt
    s_waitcnt lgkmcnt(0)
    v_mfma_f32_16x16x32_bf16 v[76:79], v[96:99], v[32:35], v[76:79]
    v_mfma_f32_16x16x32_bf16 v[76:79], v[100:103], v[36:39], v[76:79]
    v_mfma_f32_16x16x32_bf16 v[76:79], v[104:107], v[40:43], v[76:79]
    v_mfma_f32_16x16x32_bf16 v[76:79], v[108:111], v[44:47], v[76:79]
    s_nop 7
    v_max3_f32 v20, v48, v49, v50
    v_max3_f32 v20, v20, v51, v52
    v_max3_f32 v20, v20, v53, v54
    v_max3_f32 v20, v20, v55, v56
    v_max3_f32 v20, v20, v57, v58
    v_max3_f32 v20, v20, v59, v60
    v_max3_f32 v20, v20, v61, v62
    v_max3_f32 v20, v20, v63, v64
    v_max3_f32 v20, v20, v65, v66
    v_max3_f32 v20, v20, v67, v68
    v_max3_f32 v20, v20, v69, v70
    v_max3_f32 v20, v20, v71, v72
    v_max3_f32 v20, v20, v73, v74
    v_max3_f32 v20, v20, v75, v76
    v_max3_f32 v20, v20, v77, v78
    v_max_f32 v20, v20, v79
    v_mov_b32 v24, v20
    s_nop 1
    v_permlane16_swap_b32 v24, v20
    v_max_f32 v20, v20, v24
    v_mov_b32 v24, v20
    s_nop 1
    v_permlane32_swap_b32 v24, v20
    v_max_f32 v20, v20, v24
    v_subrev_u32 v6, 65, v4
    v_and_or_b32 v6, v6, s95, v8
    buffer_load_dwordx4 v[192:195], v6, s[24:27], s68 offen sc0 sc1 nt
    v_subrev_u32 v7, 69, v4
    v_and_or_b32 v7, v7, s95, v8
    buffer_load_dwordx4 v[196:199], v7, s[24:27], s69 offen sc0 sc1 nt
    v_subrev_u32 v6, 73, v4
    v_and_or_b32 v6, v6, s95, v8
    buffer_load_dwordx4 v[200:203], v6, s[24:27], s70 offen sc0 sc1 nt
    v_subrev_u32 v7, 77, v4
    v_and_or_b32 v7, v7, s95, v8
    buffer_load_dwordx4 v[204:207], v7, s[24:27], s71 offen sc0 sc1 nt
    v_pk_add_f32 v[48:49], v[48:49], v[20:21] op_sel_hi:[1,0] neg_lo:[0,1] neg_hi:[0,1]
    v_pk_add_f32 v[50:51], v[50:51], v[20:21] op_sel_hi:[1,0] neg_lo:[0,1] neg_hi:[0,1]
    v_pk_add_f32 v[52:53], v[52:53], v[20:21] op_sel_hi:[1,0] neg_lo:[0,1] neg_hi:[0,1]
    v_pk_add_f32 v[54:55], v[54:55], v[20:21] op_sel_hi:[1,0] neg_lo:[0,1] neg_hi:[0,1]
    v_pk_add_f32 v[56:57], v[56:57], v[20:21] op_sel_hi:[1,0] neg_lo:[0,1] neg_hi:[0,1]
    v_pk_add_f32 v[58:59], v[58:59], v[20:21] op_sel_hi:[1,0] neg_lo:[0,1] neg_hi:[0,1]
    v_pk_add_f32 v[60:61], v[60:61], v[20:21] op_sel_hi:[1,0] neg_lo:[0,1] neg_hi:[0,1]
    v_pk_add_f32 v[62:63], v[62:63], v[20:21] op_sel_hi:[1,0] neg_lo:[0,1] neg_hi:[0,1]
    v_pk_add_f32 v[64:65], v[64:65], v[20:21] op_sel_hi:[1,0] neg_lo:[0,1] neg_hi:[0,1]
    v_pk_add_f32 v[66:67], v[66:67], v[20:21] op_sel_hi:[1,0] neg_lo:[0,1] neg_hi:[0,1]
    v_pk_add_f32 v[68:69], v[68:69], v[20:21] op_sel_hi:[1,0] neg_lo:[0,1] neg_hi:[0,1]
    v_pk_add_f32 v[70:71], v[70:71], v[20:21] op_sel_hi:[1,0] neg_lo:[0,1] neg_hi:[0,1]
    v_pk_add_f32 v[72:73], v[72:73], v[20:21] op_sel_hi:[1,0] neg_lo:[0,1] neg_hi:[0,1]
    v_pk_add_f32 v[74:75], v[74:75], v[20:21] op_sel_hi:[1,0] neg_lo:[0,1] neg_hi:[0,1]
    v_pk_add_f32 v[76:77], v[76:77], v[20:21] op_sel_hi:[1,0] neg_lo:[0,1] neg_hi:[0,1]
    v_pk_add_f32 v[78:79], v[78:79], v[20:21] op_sel_hi:[1,0] neg_lo:[0,1] neg_hi:[0,1]
    v_pk_mul_f32 v[48:49], v[48:49], s[92:93] op_sel_hi:[1,0]
    v_pk_mul_f32 v[50:51], v[50:51], s[92:93] op_sel_hi:[1,0]
    v_pk_mul_f32 v[52:53], v[52:53], s[92:93] op_sel_hi:[1,0]
    v_pk_mul_f32 v[54:55], v[54:55], s[92:93] op_sel_hi:[1,0]
    v_pk_mul_f32 v[56:57], v[56:57], s[92:93] op_sel_hi:[1,0]
    v_pk_mul_f32 v[58:59], v[58:59], s[92:93] op_sel_hi:[1,0]
    v_pk_mul_f32 v[60:61], v[60:61], s[92:93] op_sel_hi:[1,0]
    v_pk_mul_f32 v[62:63], v[62:63], s[92:93] op_sel_hi:[1,0]
    v_pk_mul_f32 v[64:65], v[64:65], s[92:93] op_sel_hi:[1,0]
    v_pk_mul_f32 v[66:67], v[66:67], s[92:93] op_sel_hi:[1,0]
    v_pk_mul_f32 v[68:69], v[68:69], s[92:93] op_sel_hi:[1,0]
    v_pk_mul_f32 v[70:71], v[70:71], s[92:93] op_sel_hi:[1,0]
    v_pk_mul_f32 v[72:73], v[72:73], s[92:93] op_sel_hi:[1,0]
    v_pk_mul_f32 v[74:75], v[74:75], s[92:93] op_sel_hi:[1,0]
    v_pk_mul_f32 v[76:77], v[76:77], s[92:93] op_sel_hi:[1,0]
    v_pk_mul_f32 v[78:79], v[78:79], s[92:93] op_sel_hi:[1,0]
    v_exp_f32 v48, v48
    v_exp_f32 v49, v49
    v_exp_f32 v50, v50
    v_exp_f32 v51, v51
    v_exp_f32 v52, v52
    v_exp_f32 v53, v53
    v_exp_f32 v54, v54
    v_exp_f32 v55, v55
    v_exp_f32 v56, v56
    v_exp_f32 v57, v57
    v_exp_f32 v58, v58
    v_exp_f32 v59, v59
    v_exp_f32 v60, v60
    v_exp_f32 v61, v61
    v_exp_f32 v62, v62
    v_exp_f32 v63, v63
    v_exp_f32 v64, v64
    v_exp_f32 v65, v65
    v_exp_f32 v66, v66
    v_exp_f32 v67, v67
    v_exp_f32 v68, v68
    v_exp_f32 v69, v69
    v_exp_f32 v70, v70
    v_exp_f32 v71, v71
    v_exp_f32 v72, v72
    v_exp_f32 v73, v73
    v_exp_f32 v74, v74
    v_exp_f32 v75, v75
    v_exp_f32 v76, v76
    v_exp_f32 v77, v77
    v_exp_f32 v78, v78
    v_exp_f32 v79, v79
    s_nop 0
    v_subrev_u32 v6, 81, v4
    v_and_or_b32 v6, v6, s95, v8
    buffer_load_dwordx4 v[208:211], v6, s[24:27], s72 offen sc0 sc1 nt
    v_subrev_u32 v7, 85, v4
    v_and_or_b32 v7, v7, s95, v8
    buffer_load_dwordx4 v[212:215], v7, s[24:27], s73 offen sc0 sc1 nt
    v_subrev_u32 v6, 89, v4
    v_and_or_b32 v6, v6, s95, v8
    buffer_load_dwordx4 v[216:219], v6, s[24:27], s74 offen sc0 sc1 nt
    v_subrev_u32 v7, 93, v4
    v_and_or_b32 v7, v7, s95, v8
    buffer_load_dwordx4 v[220:223], v7, s[24:27], s75 offen sc0 sc1 nt
    v_pk_add_f32 v[24:25], v[48:49], v[50:51]
    v_pk_add_f32 v[24:25], v[24:25], v[52:53]
    v_pk_add_f32 v[24:25], v[24:25], v[54:55]
    v_pk_add_f32 v[24:25], v[24:25], v[56:57]
    v_pk_add_f32 v[24:25], v[24:25], v[58:59]
    v_pk_add_f32 v[24:25], v[24:25], v[60:61]
    v_pk_add_f32 v[24:25], v[24:25], v[62:63]
    v_pk_add_f32 v[24:25], v[24:25], v[64:65]
    v_pk_add_f32 v[24:25], v[24:25], v[66:67]
    v_pk_add_f32 v[24:25], v[24:25], v[68:69]
    v_pk_add_f32 v[24:25], v[24:25], v[70:71]
    v_pk_add_f32 v[24:25], v[24:25], v[72:73]
    v_pk_add_f32 v[24:25], v[24:25], v[74:75]
    v_pk_add_f32 v[24:25], v[24:25], v[76:77]
    v_pk_add_f32 v[24:25], v[24:25], v[78:79]
    v_add_f32 v21, v24, v25
    v_cvt_pk_bf16_f32 v48, v48, v49
    v_cvt_pk_bf16_f32 v49, v50, v51
    v_cvt_pk_bf16_f32 v50, v52, v53
    v_cvt_pk_bf16_f32 v51, v54, v55
    v_cvt_pk_bf16_f32 v56, v56, v57
    v_cvt_pk_bf16_f32 v57, v58, v59
    v_cvt_pk_bf16_f32 v58, v60, v61
    v_cvt_pk_bf16_f32 v59, v62, v63
    v_cvt_pk_bf16_f32 v64, v64, v65
    v_cvt_pk_bf16_f32 v65, v66, v67
    v_cvt_pk_bf16_f32 v66, v68, v69
    v_cvt_pk_bf16_f32 v67, v70, v71
    v_cvt_pk_bf16_f32 v72, v72, v73
    v_cvt_pk_bf16_f32 v73, v74, v75
    v_cvt_pk_bf16_f32 v74, v76, v77
    v_cvt_pk_bf16_f32 v75, v78, v79
    v_mov_b32 v24, v21
    s_nop 1
    v_permlane16_swap_b32 v24, v21
    v_add_f32 v21, v21, v24
    v_mov_b32 v24, v21
    s_nop 1
    v_permlane32_swap_b32 v24, v21
    v_add_f32 v21, v21, v24
    s_waitcnt vmcnt(16)
    v_perm_b32 v52, v132, v128, s93
    v_perm_b32 v53, v140, v136, s93
    v_perm_b32 v54, v148, v144, s93
    v_perm_b32 v55, v156, v152, s93
    v_perm_b32 v60, v132, v128, s94
    v_perm_b32 v61, v140, v136, s94
    v_perm_b32 v62, v148, v144, s94
    v_perm_b32 v63, v156, v152, s94
    v_mfma_f32_16x16x32_bf16 v[80:83], v[48:51], v[52:55], 0
    v_perm_b32 v68, v133, v129, s93
    v_perm_b32 v69, v141, v137, s93
    v_perm_b32 v70, v149, v145, s93
    v_perm_b32 v71, v157, v153, s93
    v_mfma_f32_16x16x32_bf16 v[84:87], v[48:51], v[60:63], 0
    v_perm_b32 v76, v133, v129, s94
    v_perm_b32 v77, v141, v137, s94
    v_perm_b32 v78, v149, v145, s94
    v_perm_b32 v79, v157, v153, s94
    v_mfma_f32_16x16x32_bf16 v[88:91], v[48:51], v[68:71], 0
    v_perm_b32 v52, v134, v130, s93
    v_perm_b32 v53, v142, v138, s93
    v_perm_b32 v54, v150, v146, s93
    v_perm_b32 v55, v158, v154, s93
    v_mfma_f32_16x16x32_bf16 v[92:95], v[48:51], v[76:79], 0
    v_perm_b32 v60, v134, v130, s94
    v_perm_b32 v61, v142, v138, s94
    v_perm_b32 v62, v150, v146, s94
    v_perm_b32 v63, v158, v154, s94
    v_mfma_f32_16x16x32_bf16 v[96:99], v[48:51], v[52:55], 0
    v_perm_b32 v68, v135, v131, s93
    v_perm_b32 v69, v143, v139, s93
    v_perm_b32 v70, v151, v147, s93
    v_perm_b32 v71, v159, v155, s93
    v_mfma_f32_16x16x32_bf16 v[100:103], v[48:51], v[60:63], 0
    v_perm_b32 v76, v135, v131, s94
    v_perm_b32 v77, v143, v139, s94
    v_perm_b32 v78, v151, v147, s94
    v_perm_b32 v79, v159, v155, s94
    v_mfma_f32_16x16x32_bf16 v[104:107], v[48:51], v[68:71], 0
    s_nop 0
    v_mfma_f32_16x16x32_bf16 v[108:111], v[48:51], v[76:79], 0
    v_subrev_u32 v6, 97, v4
    v_and_or_b32 v6, v6, s95, v8
    buffer_load_dwordx4 v[224:227], v6, s[24:27], s76 offen sc0 sc1 nt
    v_subrev_u32 v7, 101, v4
    v_and_or_b32 v7, v7, s95, v8
    buffer_load_dwordx4 v[228:231], v7, s[24:27], s77 offen sc0 sc1 nt
    v_subrev_u32 v6, 105, v4
    v_and_or_b32 v6, v6, s95, v8
    buffer_load_dwordx4 v[232:235], v6, s[24:27], s78 offen sc0 sc1 nt
    v_subrev_u32 v7, 109, v4
    v_and_or_b32 v7, v7, s95, v8
    buffer_load_dwordx4 v[236:239], v7, s[24:27], s79 offen sc0 sc1 nt
    s_waitcnt vmcnt(12)
    v_perm_b32 v52, v164, v160, s93
    v_perm_b32 v53, v172, v168, s93
    v_perm_b32 v54, v180, v176, s93
    v_perm_b32 v55, v188, v184, s93
    v_perm_b32 v60, v164, v160, s94
    v_perm_b32 v61, v172, v168, s94
    v_perm_b32 v62, v180, v176, s94
    v_perm_b32 v63, v188, v184, s94
    v_mfma_f32_16x16x32_bf16 v[80:83], v[56:59], v[52:55], v[80:83]
    v_perm_b32 v68, v165, v161, s93
    v_perm_b32 v69, v173, v169, s93
    v_perm_b32 v70, v181, v177, s93
    v_perm_b32 v71, v189, v185, s93
    v_mfma_f32_16x16x32_bf16 v[84:87], v[56:59], v[60:63], v[84:87]
    v_perm_b32 v76, v165, v161, s94
    v_perm_b32 v77, v173, v169, s94
    v_perm_b32 v78, v181, v177, s94
    v_perm_b32 v79, v189, v185, s94
    v_mfma_f32_16x16x32_bf16 v[88:91], v[56:59], v[68:71], v[88:91]
    v_perm_b32 v52, v166, v162, s93
    v_perm_b32 v53, v174, v170, s93
    v_perm_b32 v54, v182, v178, s93
    v_perm_b32 v55, v190, v186, s93
    v_mfma_f32_16x16x32_bf16 v[92:95], v[56:59], v[76:79], v[92:95]
    v_perm_b32 v60, v166, v162, s94
    v_perm_b32 v61, v174, v170, s94
    v_perm_b32 v62, v182, v178, s94
    v_perm_b32 v63, v190, v186, s94
    v_mfma_f32_16x16x32_bf16 v[96:99], v[56:59], v[52:55], v[96:99]
    v_perm_b32 v68, v167, v163, s93
    v_perm_b32 v69, v175, v171, s93
    v_perm_b32 v70, v183, v179, s93
    v_perm_b32 v71, v191, v187, s93
    v_mfma_f32_16x16x32_bf16 v[100:103], v[56:59], v[60:63], v[100:103]
    v_perm_b32 v76, v167, v163, s94
    v_perm_b32 v77, v175, v171, s94
    v_perm_b32 v78, v183, v179, s94
    v_perm_b32 v79, v191, v187, s94
    v_mfma_f32_16x16x32_bf16 v[104:107], v[56:59], v[68:71], v[104:107]
    s_nop 0
    v_mfma_f32_16x16x32_bf16 v[108:111], v[56:59], v[76:79], v[108:111]
    v_subrev_u32 v6, 113, v4
    v_and_or_b32 v6, v6, s95, v8
    buffer_load_dwordx4 v[240:243], v6, s[24:27], s80 offen sc0 sc1 nt
    v_subrev_u32 v7, 117, v4
    v_and_or_b32 v7, v7, s95, v8
    buffer_load_dwordx4 v[244:247], v7, s[24:27], s81 offen sc0 sc1 nt
    v_subrev_u32 v6, 121, v4
    v_and_or_b32 v6, v6, s95, v8
    buffer_load_dwordx4 v[248:251], v6, s[24:27], s82 offen sc0 sc1 nt
    v_subrev_u32 v7, 125, v4
    v_and_or_b32 v7, v7, s95, v8
    buffer_load_dwordx4 v[252:255], v7, s[24:27], s83 offen sc0 sc1 nt
    s_load_dwordx8 s[52:59], s[12:13], 0
    s_lshl_b32 s90, s84, 3
    s_add_u32 s90, s90, s0
    s_mul_i32 s60, s90, 192
    s_add_u32 s60, s60, s85
    s_add_u32 s60, s60, 22
    s_lshl_b32 s60, s60, 8
    s_mul_i32 s61, s90, 26
    s_add_u32 s61, s61, s85
    s_lshl_b32 s61, s61, 7
    s_add_u32 s61, s61, 3190784
    s_cmp_ge_u32 s89, 4
    s_cselect_b32 s61, s61, s95
    v_mul_u32_u24 v24, 12288, v2
    v_lshl_add_u32 v24, v3, 4, v24
    v_lshlrev_b32 v25, 3, v3
    s_cmp_lt_u32 s89, 4
    s_cbranch_scc1 L_P_nm
    s_and_b32 s90, s89, 3
    s_lshl_b32 s91, s90, 8
    s_add_u32 s91, s91, 131072
    v_lshl_add_u32 v6, v3, 3, s91
    s_lshl_b32 s90, s90, 14
    v_lshl_add_u32 v7, v1, 4, s90
    s_waitcnt lgkmcnt(0)
    s_barrier
    ds_read_b64 v[36:37], v6 offset:0
    ds_read_b128 v[128:131], v7 offset:0
    ds_read_b128 v[132:135], v7 offset:1024
    ds_read_b128 v[136:139], v7 offset:2048
    ds_read_b128 v[140:143], v7 offset:3072
    ds_read_b128 v[144:147], v7 offset:4096
    ds_read_b128 v[148:151], v7 offset:5120
    ds_read_b128 v[152:155], v7 offset:6144
    ds_read_b128 v[156:159], v7 offset:7168
    s_waitcnt lgkmcnt(8)
    v_lshl_add_u32 v6, v3, 2, s91
    v_lshl_add_u32 v7, v2, 4, s91
    v_max_f32 v38, v20, v36
    v_sub_f32 v36, v36, v38
    v_sub_f32 v40, v20, v38
    v_mul_f32 v36, s92, v36
    v_mul_f32 v40, s92, v40
    v_exp_f32 v36, v36
    v_exp_f32 v40, v40
    v_mov_b32 v20, v38
    v_mul_f32 v21, v21, v40
    v_fmac_f32 v21, v36, v37
    ds_write_b32 v6, v36 offset:1024
    ds_write_b32 v6, v40 offset:1088
    s_waitcnt lgkmcnt(0)
    ds_read_b128 v[36:39], v7 offset:1024
    ds_read_b128 v[40:43], v7 offset:1088
    s_waitcnt lgkmcnt(0)
    v_mul_f32 v128, v128, v36
    v_mul_f32 v132, v132, v36
    v_mul_f32 v136, v136, v36
    v_mul_f32 v140, v140, v36
    v_mul_f32 v144, v144, v36
    v_mul_f32 v148, v148, v36
    v_mul_f32 v152, v152, v36
    v_mul_f32 v156, v156, v36
L_P_nm:
    s_waitcnt vmcnt(8)
    v_perm_b32 v52, v196, v192, s93
    v_perm_b32 v53, v204, v200, s93
    v_perm_b32 v54, v212, v208, s93
    v_perm_b32 v55, v220, v216, s93
    v_perm_b32 v60, v196, v192, s94
    v_perm_b32 v61, v204, v200, s94
    v_perm_b32 v62, v212, v208, s94
    v_perm_b32 v63, v220, v216, s94
    v_mfma_f32_16x16x32_bf16 v[80:83], v[64:67], v[52:55], v[80:83]
    v_perm_b32 v68, v197, v193, s93
    v_perm_b32 v69, v205, v201, s93
    v_perm_b32 v70, v213, v209, s93
    v_perm_b32 v71, v221, v217, s93
    v_mfma_f32_16x16x32_bf16 v[84:87], v[64:67], v[60:63], v[84:87]
    v_perm_b32 v76, v197, v193, s94
    v_perm_b32 v77, v205, v201, s94
    v_perm_b32 v78, v213, v209, s94
    v_perm_b32 v79, v221, v217, s94
    v_mfma_f32_16x16x32_bf16 v[88:91], v[64:67], v[68:71], v[88:91]
    v_perm_b32 v52, v198, v194, s93
    v_perm_b32 v53, v206, v202, s93
    v_perm_b32 v54, v214, v210, s93
    v_perm_b32 v55, v222, v218, s93
    v_mfma_f32_16x16x32_bf16 v[92:95], v[64:67], v[76:79], v[92:95]
    v_perm_b32 v60, v198, v194, s94
    v_perm_b32 v61, v206, v202, s94
    v_perm_b32 v62, v214, v210, s94
    v_perm_b32 v63, v222, v218, s94
    v_mfma_f32_16x16x32_bf16 v[96:99], v[64:67], v[52:55], v[96:99]
    v_perm_b32 v68, v199, v195, s93
    v_perm_b32 v69, v207, v203, s93
    v_perm_b32 v70, v215, v211, s93
    v_perm_b32 v71, v223, v219, s93
    v_mfma_f32_16x16x32_bf16 v[100:103], v[64:67], v[60:63], v[100:103]
    v_perm_b32 v76, v199, v195, s94
    v_perm_b32 v77, v207, v203, s94
    v_perm_b32 v78, v215, v211, s94
    v_perm_b32 v79, v223, v219, s94
    v_mfma_f32_16x16x32_bf16 v[104:107], v[64:67], v[68:71], v[104:107]
    s_nop 0
    v_mfma_f32_16x16x32_bf16 v[108:111], v[64:67], v[76:79], v[108:111]
    s_waitcnt vmcnt(0)
    v_perm_b32 v52, v228, v224, s93
    v_perm_b32 v53, v236, v232, s93
    v_perm_b32 v54, v244, v240, s93
    v_perm_b32 v55, v252, v248, s93
    v_perm_b32 v60, v228, v224, s94
    v_perm_b32 v61, v236, v232, s94
    v_perm_b32 v62, v244, v240, s94
    v_perm_b32 v63, v252, v248, s94
    v_mfma_f32_16x16x32_bf16 v[80:83], v[72:75], v[52:55], v[80:83]
    v_perm_b32 v68, v229, v225, s93
    v_perm_b32 v69, v237, v233, s93
    v_perm_b32 v70, v245, v241, s93
    v_perm_b32 v71, v253, v249, s93
    v_mfma_f32_16x16x32_bf16 v[84:87], v[72:75], v[60:63], v[84:87]
    v_perm_b32 v76, v229, v225, s94
    v_perm_b32 v77, v237, v233, s94
    v_perm_b32 v78, v245, v241, s94
    v_perm_b32 v79, v253, v249, s94
    v_mfma_f32_16x16x32_bf16 v[88:91], v[72:75], v[68:71], v[88:91]
    v_perm_b32 v52, v230, v226, s93
    v_perm_b32 v53, v238, v234, s93
    v_perm_b32 v54, v246, v242, s93
    v_perm_b32 v55, v254, v250, s93
    v_mfma_f32_16x16x32_bf16 v[92:95], v[72:75], v[76:79], v[92:95]
    v_perm_b32 v60, v230, v226, s94
    v_perm_b32 v61, v238, v234, s94
    v_perm_b32 v62, v246, v242, s94
    v_perm_b32 v63, v254, v250, s94
    v_mfma_f32_16x16x32_bf16 v[96:99], v[72:75], v[52:55], v[96:99]
    v_perm_b32 v68, v231, v227, s93
    v_perm_b32 v69, v239, v235, s93
    v_perm_b32 v70, v247, v243, s93
    v_perm_b32 v71, v255, v251, s93
    v_mfma_f32_16x16x32_bf16 v[100:103], v[72:75], v[60:63], v[100:103]
    v_perm_b32 v76, v231, v227, s94
    v_perm_b32 v77, v239, v235, s94
    v_perm_b32 v78, v247, v243, s94
    v_perm_b32 v79, v255, v251, s94
    v_mfma_f32_16x16x32_bf16 v[104:107], v[72:75], v[68:71], v[104:107]
    s_nop 0
    v_mfma_f32_16x16x32_bf16 v[108:111], v[72:75], v[76:79], v[108:111]
    s_cmp_ge_u32 s89, 4
    s_cbranch_scc1 L_P_fin
    s_lshl_b32 s91, s89, 8
    s_add_u32 s91, s91, 131072
    v_lshl_add_u32 v6, v3, 3, s91
    v_lshl_add_u32 v7, v1, 4, s96
    s_nop 3
    ds_write_b64 v6, v[20:21] offset:0
    ds_write_b128 v7, v[80:83] offset:0
    ds_write_b128 v7, v[84:87] offset:1024
    ds_write_b128 v7, v[88:91] offset:2048
    ds_write_b128 v7, v[92:95] offset:3072
    ds_write_b128 v7, v[96:99] offset:4096
    ds_write_b128 v7, v[100:103] offset:5120
    ds_write_b128 v7, v[104:107] offset:6144
    ds_write_b128 v7, v[108:111] offset:7168
    s_waitcnt lgkmcnt(0)
    s_barrier
    s_branch L_P_more
L_P_fin:
    s_nop 5
    v_fma_f32 v80, v80, v40, v128
    v_fma_f32 v84, v84, v40, v132
    v_fma_f32 v88, v88, v40, v136
    v_fma_f32 v92, v92, v40, v140
    v_fma_f32 v96, v96, v40, v144
    v_fma_f32 v100, v100, v40, v148
    v_fma_f32 v104, v104, v40, v152
    v_fma_f32 v108, v108, v40, v156
    s_mov_b64 exec, 0xffff
    buffer_store_dwordx2 v[20:21], v25, s[32:35], s61 offen sc1
    s_mov_b64 exec, -1
    v_cvt_pk_bf16_f32 v32, v80, v84
    v_cvt_pk_bf16_f32 v33, v88, v92
    v_cvt_pk_bf16_f32 v34, v96, v100
    v_cvt_pk_bf16_f32 v35, v104, v108
    buffer_store_dwordx4 v[32:35], v24, s[32:35], s60 offen sc1
L_P_more:
    s_waitcnt lgkmcnt(0)
    s_sub_u32 s90, s52, 1
    s_cmp_ge_u32 s90, 7760
    s_cbranch_scc1 L_P_next
    s_sub_u32 s90, s53, 1
    s_cmp_ge_u32 s90, 7328
    s_cbranch_scc1 L_P_next
    s_sub_u32 s90, s54, 1
    s_cmp_ge_u32 s90, 6896
    s_cbranch_scc1 L_P_next
    s_sub_u32 s90, s55, 1
    s_cmp_ge_u32 s90, 6460
    s_cbranch_scc1 L_P_next
    s_sub_u32 s90, s56, 1
    s_cmp_ge_u32 s90, 8076
    s_cbranch_scc1 L_P_next
    s_sub_u32 s90, s57, 1
    s_cmp_ge_u32 s90, 7644
    s_cbranch_scc1 L_P_next
    s_sub_u32 s90, s58, 1
    s_cmp_ge_u32 s90, 7212
    s_cbranch_scc1 L_P_next
    s_sub_u32 s90, s59, 1
    s_cmp_ge_u32 s90, 6776
    s_cbranch_scc1 L_P_next
    s_branch L_done
L_P_next:
    s_cmp_lg_u32 s50, 0
    s_cbranch_scc1 L_done
    s_cmp_ge_u32 s2, 110
    s_cbranch_scc1 L_done
    s_mov_b32 s50, 1
    s_mov_b32 s68, 0xf28f102c
    s_cmp_ge_u32 s2, 48
    s_cselect_b32 s68, 0xe50d2130, s68
    s_cmp_ge_u32 s2, 56
    s_cselect_b32 s68, 0xd78c3238, s68
    s_cmp_ge_u32 s2, 68
    s_cselect_b32 s68, 0xc9ea3b44, s68
    s_cmp_ge_u32 s2, 82
    s_cselect_b32 s68, 0xfc710c52, s68
    s_cmp_ge_u32 s2, 84
    s_cselect_b32 s68, 0xeeef1d54, s68
    s_cmp_ge_u32 s2, 90
    s_cselect_b32 s68, 0xe16d265a, s68
    s_cmp_ge_u32 s2, 98
    s_cselect_b32 s68, 0xd3cb3762, s68
    s_and_b32 s70, s68, 255
    s_sub_u32 s70, s2, s70
    s_bfe_u32 s84, s68, 0x30008
    s_bfe_u32 s72, s68, 0x5000b
    s_bfe_u32 s85, s68, 0x50010
    s_lshr_b32 s68, s68, 21
    s_mov_b32 s69, 64
    s_mov_b32 s73, 0
    s_cmp_ge_u32 s70, s72
    s_cselect_b32 s0, 4, 0
    s_cselect_b32 s75, s72, 0
    s_sub_u32 s70, s70, s75
    s_and_b32 s75, s89, 3
    s_add_u32 s0, s0, s75
    s_mul_i32 s71, s70, s69
    s_min_u32 s75, s70, s73
    s_cselect_b32 s76, 1, 0
    s_add_u32 s71, s71, s75
    s_add_u32 s71, s71, s68
    s_add_u32 s76, s76, s69
    s_add_u32 s75, s71, s76
    s_min_u32 s75, s75, 2048
    s_add_u32 s76, s71, s75
    s_add_u32 s76, s76, 1
    s_lshr_b32 s76, s76, 1
    s_lshl_b32 s1, s71, 2
    s_cmp_ge_u32 s89, 4
    s_cselect_b32 s71, s76, s71
    s_cselect_b32 s75, s75, s76
    s_lshl_b32 s86, s71, 2
    s_lshl_b32 s97, s75, 2
    s_add_u32 s85, s85, s70
    s_lshl_b32 s49, s84, 2
    s_load_dword s3, s[12:13], s49
    s_waitcnt lgkmcnt(0)
    s_sub_u32 s90, s3, 1
    s_cmp_lt_u32 s90, s1
    s_cbranch_scc1 L_done
    s_mov_b32 s88, 0
    s_waitcnt vmcnt(0)
    s_barrier
    s_branch L_P_job
L_S:
    s_mov_b32 s70, s2
    s_mov_b32 s72, 22
    s_mov_b32 s69, 46
    s_mov_b32 s73, 12
    s_cmp_ge_u32 s70, s72
    s_cselect_b32 s0, 4, 0
    s_cselect_b32 s75, s72, 0
    s_sub_u32 s70, s70, s75
    s_and_b32 s75, s89, 3
    s_add_u32 s0, s0, s75
    s_mul_i32 s71, s70, s69
    s_min_u32 s75, s70, s73
    s_cselect_b32 s76, 1, 0
    s_add_u32 s71, s71, s75
    s_add_u32 s71, s71, 0
    s_add_u32 s76, s76, s69
    s_add_u32 s75, s71, s76
    s_add_u32 s76, s71, s75
    s_add_u32 s76, s76, 1
    s_lshr_b32 s76, s76, 1
    s_lshl_b32 s1, s71, 2
    s_cmp_ge_u32 s89, 4
    s_cselect_b32 s71, s76, s71
    s_cselect_b32 s75, s75, s76
    s_lshl_b32 s86, s71, 2
    s_lshl_b32 s97, s75, 2
    s_mov_b32 s85, s70
    s_sub_u32 s88, s97, s86
    s_mov_b32 s84, 0
    s_lshl_b32 s91, s84, 12
    s_add_u32 s91, s91, s86
    s_lshl_b32 s91, s91, 3
    s_add_u32 s91, s91, s0
    s_lshl_b32 s40, s91, 8
    v_sub_u32 v4, s88, v2
    v_lshlrev_b32 v5, 13, v2
    v_and_b32 v24, 12, v3
    s_lshl_b32 s90, s84, 11
    s_lshr_b32 s91, s86, 4
    s_lshl_b32 s91, s91, 2
    s_add_u32 s90, s90, s91
    s_add_u32 s91, s90, 32
    s_waitcnt lgkmcnt(0)
    s_mov_b32 s36, s10
    s_mov_b32 s37, s11
    s_mov_b32 s20, s6
    s_mov_b32 s21, s7
    s_buffer_load_dwordx8 s[68:75], s[36:39], s90
    s_buffer_load_dword s76, s[36:39], s91
    s_add_u32 s52, s40, 0
    s_add_u32 m0, s96, 0
    v_subrev_u32 v6, 1, v4
    v_and_or_b32 v6, v6, s95, v12
    buffer_load_dwordx4 v6, s[20:23], s52 offen sc0 sc1 nt lds
    s_add_u32 s53, s40, 8192
    s_add_u32 m0, s96, 1024
    v_subrev_u32 v7, 5, v4
    v_and_or_b32 v7, v7, s95, v13
    buffer_load_dwordx4 v7, s[20:23], s53 offen sc0 sc1 nt lds
    s_add_u32 s54, s40, 16384
    s_add_u32 m0, s96, 2048
    v_subrev_u32 v6, 9, v4
    v_and_or_b32 v6, v6, s95, v14
    buffer_load_dwordx4 v6, s[20:23], s54 offen sc0 sc1 nt lds
    s_add_u32 s55, s40, 24576
    s_add_u32 m0, s96, 3072
    v_subrev_u32 v7, 13, v4
    v_and_or_b32 v7, v7, s95, v15
    buffer_load_dwordx4 v7, s[20:23], s55 offen sc0 sc1 nt lds
    s_add_u32 s56, s40, 32768
    s_add_u32 m0, s96, 4096
    v_subrev_u32 v6, 17, v4
    v_and_or_b32 v6, v6, s95, v12
    buffer_load_dwordx4 v6, s[20:23], s56 offen sc0 sc1 nt lds
    s_add_u32 s57, s40, 40960
    s_add_u32 m0, s96, 5120
    v_subrev_u32 v7, 21, v4
    v_and_or_b32 v7, v7, s95, v13
    buffer_load_dwordx4 v7, s[20:23], s57 offen sc0 sc1 nt lds
    s_add_u32 s58, s40, 49152
    s_add_u32 m0, s96, 6144
    v_subrev_u32 v6, 25, v4
    v_and_or_b32 v6, v6, s95, v14
    buffer_load_dwordx4 v6, s[20:23], s58 offen sc0 sc1 nt lds
    s_add_u32 s59, s40, 57344
    s_add_u32 m0, s96, 7168
    v_subrev_u32 v7, 29, v4
    v_and_or_b32 v7, v7, s95, v15
    buffer_load_dwordx4 v7, s[20:23], s59 offen sc0 sc1 nt lds
    s_mov_b32 s28, s4
    s_mov_b32 s29, s5
    s_mov_b32 s31, 0x20000
    s_mov_b32 s30, 65536
    s_lshr_b32 s90, s1, 4
    v_and_b32 v6, 7, v1
    v_add_u32 v6, s90, v6
    v_lshrrev_b32 v7, 3, v1
    v_lshlrev_b32 v7, 11, v7
    v_min_u32 v156, 255, v6
    v_lshlrev_b32 v156, 2, v156
    v_add_u32 v157, v7, v156
    buffer_load_dword v124, v156, s[36:39], 0 offen
    buffer_load_dword v125, v157, s[36:39], 0 offen
    v_add_u32 v6, 8, v6
    v_min_u32 v156, 255, v6
    v_lshlrev_b32 v156, 2, v156
    v_add_u32 v157, v7, v156
    buffer_load_dword v126, v156, s[36:39], 0 offen
    buffer_load_dword v127, v157, s[36:39], 0 offen
    global_load_dword v28, v24, s[12:13]
    global_load_dword v29, v24, s[12:13] offset:16
    v_lshl_add_u32 v8, v3, 4, v30
    s_mov_b32 s92, 0x3e0293ee
    s_mov_b32 s93, 0x05040100
    s_mov_b32 s94, 0x07060302
    v_and_b32 v6, 3, v3
    v_lshrrev_b32 v7, 2, v3
    v_lshl_add_u32 v6, v6, 2, v7
    v_lshlrev_b32 v6, 8, v6
    v_add_u32 v6, s96, v6
    v_xor_b32 v7, v2, v3
    v_xor_b32 v16, 0, v7
    v_lshl_add_u32 v16, v16, 4, v6
    v_xor_b32 v17, 4, v7
    v_lshl_add_u32 v17, v17, 4, v6
    v_xor_b32 v18, 8, v7
    v_lshl_add_u32 v18, v18, 4, v6
    v_xor_b32 v19, 12, v7
    v_lshl_add_u32 v19, v19, 4, v6
    s_mov_b32 s24, s8
    s_mov_b32 s25, s9
    s_mov_b32 s26, 75497472
    s_mov_b32 s27, 0x20000
    s_mov_b32 s32, s18
    s_mov_b32 s33, s19
    s_mov_b32 s34, 301989888
    s_mov_b32 s35, 0x20000
    s_mov_b32 s49, 0
    s_mov_b32 s51, 2
L_S_iter:
    s_lshl_b32 s90, s0, 10
    s_add_u32 s91, s90, 32768
    v_xor_b32 v6, 0, v0
    v_lshl_add_u32 v6, v6, 4, v5
    v_add_u32 v6, 0, v6
    s_add_u32 m0, s96, 8192
    s_nop 0
    buffer_load_dwordx4 v6, s[28:31], s90 offen lds
    s_add_u32 m0, s96, 12288
    s_nop 0
    buffer_load_dwordx4 v6, s[28:31], s91 offen lds
    v_xor_b32 v7, 1, v0
    v_lshl_add_u32 v7, v7, 4, v5
    v_add_u32 v7, 256, v7
    s_add_u32 m0, s96, 9216
    s_nop 0
    buffer_load_dwordx4 v7, s[28:31], s90 offen lds
    s_add_u32 m0, s96, 13312
    s_nop 0
    buffer_load_dwordx4 v7, s[28:31], s91 offen lds
    v_xor_b32 v6, 2, v0
    v_lshl_add_u32 v6, v6, 4, v5
    v_add_u32 v6, 512, v6
    s_add_u32 m0, s96, 10240
    s_nop 0
    buffer_load_dwordx4 v6, s[28:31], s90 offen lds
    s_add_u32 m0, s96, 14336
    s_nop 0
    buffer_load_dwordx4 v6, s[28:31], s91 offen lds
    v_xor_b32 v7, 3, v0
    v_lshl_add_u32 v7, v7, 4, v5
    v_add_u32 v7, 768, v7
    s_add_u32 m0, s96, 11264
    s_nop 0
    buffer_load_dwordx4 v7, s[28:31], s90 offen lds
    s_add_u32 m0, s96, 15360
    s_nop 0
    buffer_load_dwordx4 v7, s[28:31], s91 offen lds
    s_waitcnt lgkmcnt(0)
    s_bfe_u32 s87, s86, 0x20002
    s_lshl_b32 s90, s0, 8
    s_lshr_b32 s91, s40, 15
    s_cmp_lg_u32 s68, s91
    s_cselect_b32 s49, 1, s49
    s_add_u32 s91, s91, 1
    s_cmp_lg_u32 s69, s91
    s_cselect_b32 s49, 1, s49
    s_add_u32 s91, s91, 1
    s_cmp_lg_u32 s70, s91
    s_cselect_b32 s49, 1, s49
    s_add_u32 s91, s91, 1
    s_cmp_lg_u32 s71, s91
    s_cselect_b32 s49, 1, s49
    s_add_u32 s91, s91, 1
    s_cmp_lg_u32 s72, s91
    s_cselect_b32 s49, 1, s49
    s_lshl_b32 s40, s68, 15
    s_add_u32 s40, s40, s90
    s_lshl_b32 s41, s69, 15
    s_add_u32 s41, s41, s90
    s_lshl_b32 s42, s70, 15
    s_add_u32 s42, s42, s90
    s_lshl_b32 s43, s71, 15
    s_add_u32 s43, s43, s90
    s_lshl_b32 s44, s72, 15
    s_add_u32 s44, s44, s90
    s_lshl_b32 s45, s73, 15
    s_add_u32 s45, s45, s90
    s_lshl_b32 s46, s74, 15
    s_add_u32 s46, s46, s90
    s_lshl_b32 s47, s75, 15
    s_add_u32 s47, s47, s90
    s_lshl_b32 s48, s76, 15
    s_add_u32 s48, s48, s90
    s_cmp_eq_u32 s49, 0
    s_cbranch_scc1 L_S_ok
    s_waitcnt vmcnt(0)
    s_add_u32 s90, s87, 0
    s_and_b32 s91, s90, 3
    s_lshl_b32 s91, s91, 13
    s_cmp_ge_u32 s90, 4
    s_cselect_b32 s52, s41, s40
    s_cselect_b32 s56, s42, s41
    s_add_u32 s52, s52, s91
    s_add_u32 s56, s56, s91
    s_add_u32 s90, s87, 1
    s_and_b32 s91, s90, 3
    s_lshl_b32 s91, s91, 13
    s_cmp_ge_u32 s90, 4
    s_cselect_b32 s53, s41, s40
    s_cselect_b32 s57, s42, s41
    s_add_u32 s53, s53, s91
    s_add_u32 s57, s57, s91
    s_add_u32 s90, s87, 2
    s_and_b32 s91, s90, 3
    s_lshl_b32 s91, s91, 13
    s_cmp_ge_u32 s90, 4
    s_cselect_b32 s54, s41, s40
    s_cselect_b32 s58, s42, s41
    s_add_u32 s54, s54, s91
    s_add_u32 s58, s58, s91
    s_add_u32 s90, s87, 3
    s_and_b32 s91, s90, 3
    s_lshl_b32 s91, s91, 13
    s_cmp_ge_u32 s90, 4
    s_cselect_b32 s55, s41, s40
    s_cselect_b32 s59, s42, s41
    s_add_u32 s55, s55, s91
    s_add_u32 s59, s59, s91
    s_add_u32 m0, s96, 0
    v_subrev_u32 v6, 1, v4
    v_and_or_b32 v6, v6, s95, v12
    buffer_load_dwordx4 v6, s[20:23], s52 offen sc0 sc1 nt lds
    s_add_u32 m0, s96, 1024
    v_subrev_u32 v7, 5, v4
    v_and_or_b32 v7, v7, s95, v13
    buffer_load_dwordx4 v7, s[20:23], s53 offen sc0 sc1 nt lds
    s_add_u32 m0, s96, 2048
    v_subrev_u32 v6, 9, v4
    v_and_or_b32 v6, v6, s95, v14
    buffer_load_dwordx4 v6, s[20:23], s54 offen sc0 sc1 nt lds
    s_add_u32 m0, s96, 3072
    v_subrev_u32 v7, 13, v4
    v_and_or_b32 v7, v7, s95, v15
    buffer_load_dwordx4 v7, s[20:23], s55 offen sc0 sc1 nt lds
    s_add_u32 m0, s96, 4096
    v_subrev_u32 v6, 17, v4
    v_and_or_b32 v6, v6, s95, v12
    buffer_load_dwordx4 v6, s[20:23], s56 offen sc0 sc1 nt lds
    s_add_u32 m0, s96, 5120
    v_subrev_u32 v7, 21, v4
    v_and_or_b32 v7, v7, s95, v13
    buffer_load_dwordx4 v7, s[20:23], s57 offen sc0 sc1 nt lds
    s_add_u32 m0, s96, 6144
    v_subrev_u32 v6, 25, v4
    v_and_or_b32 v6, v6, s95, v14
    buffer_load_dwordx4 v6, s[20:23], s58 offen sc0 sc1 nt lds
    s_add_u32 m0, s96, 7168
    v_subrev_u32 v7, 29, v4
    v_and_or_b32 v7, v7, s95, v15
    buffer_load_dwordx4 v7, s[20:23], s59 offen sc0 sc1 nt lds
    s_waitcnt vmcnt(0)
L_S_ok:
    s_add_u32 s90, s87, 0
    s_and_b32 s91, s90, 3
    s_lshl_b32 s91, s91, 13
    s_cmp_ge_u32 s90, 4
    s_cselect_b32 s60, s43, s42
    s_cselect_b32 s64, s44, s43
    s_cselect_b32 s68, s45, s44
    s_cselect_b32 s72, s46, s45
    s_add_u32 s60, s60, s91
    s_add_u32 s64, s64, s91
    s_add_u32 s68, s68, s91
    s_add_u32 s72, s72, s91
    s_add_u32 s90, s87, 1
    s_and_b32 s91, s90, 3
    s_lshl_b32 s91, s91, 13
    s_cmp_ge_u32 s90, 4
    s_cselect_b32 s61, s43, s42
    s_cselect_b32 s65, s44, s43
    s_cselect_b32 s69, s45, s44
    s_cselect_b32 s73, s46, s45
    s_add_u32 s61, s61, s91
    s_add_u32 s65, s65, s91
    s_add_u32 s69, s69, s91
    s_add_u32 s73, s73, s91
    s_add_u32 s90, s87, 2
    s_and_b32 s91, s90, 3
    s_lshl_b32 s91, s91, 13
    s_cmp_ge_u32 s90, 4
    s_cselect_b32 s62, s43, s42
    s_cselect_b32 s66, s44, s43
    s_cselect_b32 s70, s45, s44
    s_cselect_b32 s74, s46, s45
    s_add_u32 s62, s62, s91
    s_add_u32 s66, s66, s91
    s_add_u32 s70, s70, s91
    s_add_u32 s74, s74, s91
    s_add_u32 s90, s87, 3
    s_and_b32 s91, s90, 3
    s_lshl_b32 s91, s91, 13
    s_cmp_ge_u32 s90, 4
    s_cselect_b32 s63, s43, s42
    s_cselect_b32 s67, s44, s43
    s_cselect_b32 s71, s45, s44
    s_cselect_b32 s75, s46, s45
    s_add_u32 s63, s63, s91
    s_add_u32 s67, s67, s91
    s_add_u32 s71, s71, s91
    s_add_u32 s75, s75, s91
    s_waitcnt vmcnt(0)
    ds_read_b128 v[32:35], v16 offset:8192
    ds_read_b128 v[36:39], v17 offset:8192
    ds_read_b128 v[40:43], v18 offset:8192
    ds_read_b128 v[44:47], v19 offset:8192
    ds_read_b128 v[48:51], v16 offset:12288
    ds_read_b128 v[52:55], v17 offset:12288
    ds_read_b128 v[56:59], v18 offset:12288
    ds_read_b128 v[60:63], v19 offset:12288
    s_waitcnt lgkmcnt(0)
    s_add_u32 m0, s96, 8192
    v_subrev_u32 v6, 33, v4
    v_and_or_b32 v6, v6, s95, v12
    buffer_load_dwordx4 v6, s[20:23], s60 offen sc0 sc1 nt lds
    s_add_u32 m0, s96, 9216
    v_subrev_u32 v7, 37, v4
    v_and_or_b32 v7, v7, s95, v13
    buffer_load_dwordx4 v7, s[20:23], s61 offen sc0 sc1 nt lds
    s_add_u32 m0, s96, 10240
    v_subrev_u32 v6, 41, v4
    v_and_or_b32 v6, v6, s95, v14
    buffer_load_dwordx4 v6, s[20:23], s62 offen sc0 sc1 nt lds
    s_add_u32 m0, s96, 11264
    v_subrev_u32 v7, 45, v4
    v_and_or_b32 v7, v7, s95, v15
    buffer_load_dwordx4 v7, s[20:23], s63 offen sc0 sc1 nt lds
    s_add_u32 m0, s96, 12288
    v_subrev_u32 v6, 49, v4
    v_and_or_b32 v6, v6, s95, v12
    buffer_load_dwordx4 v6, s[20:23], s64 offen sc0 sc1 nt lds
    s_add_u32 m0, s96, 13312
    v_subrev_u32 v7, 53, v4
    v_and_or_b32 v7, v7, s95, v13
    buffer_load_dwordx4 v7, s[20:23], s65 offen sc0 sc1 nt lds
    s_add_u32 m0, s96, 14336
    v_subrev_u32 v6, 57, v4
    v_and_or_b32 v6, v6, s95, v14
    buffer_load_dwordx4 v6, s[20:23], s66 offen sc0 sc1 nt lds
    s_add_u32 m0, s96, 15360
    v_subrev_u32 v7, 61, v4
    v_and_or_b32 v7, v7, s95, v15
    buffer_load_dwordx4 v7, s[20:23], s67 offen sc0 sc1 nt lds
    s_cmp_lg_u32 s51, 2
    s_cbranch_scc1 L_S_chk
    v_xor_b32 v124, v124, v125
    v_xor_b32 v126, v126, v127
    v_or_b32 v124, v124, v126
    v_cmp_ne_u32 vcc, 0, v124
    v_add_u32 v26, -1, v28
    v_min_u32 v26, 8191, v26
    v_add_u32 v26, 1, v26
    v_subrev_u32 v26, s86, v26
    v_min_i32 v26, s88, v26
    v_sub_u32 v26, v26, v2
    v_add_u32 v27, -1, v29
    v_min_u32 v27, 8191, v27
    v_add_u32 v27, 1, v27
    v_subrev_u32 v27, s86, v27
    v_min_i32 v27, s88, v27
    v_sub_u32 v27, v27, v2
    s_cmp_eq_u64 vcc, 0
    s_cselect_b32 s51, 1, 0
L_S_chk:
    v_subrev_u32 v96, 1, v26
    v_ashrrev_i32 v96, 31, v96
    v_and_b32 v96, 0xf149f2ca, v96
    v_subrev_u32 v97, 5, v26
    v_ashrrev_i32 v97, 31, v97
    v_and_b32 v97, 0xf149f2ca, v97
    v_subrev_u32 v98, 9, v26
    v_ashrrev_i32 v98, 31, v98
    v_and_b32 v98, 0xf149f2ca, v98
    v_subrev_u32 v99, 13, v26
    v_ashrrev_i32 v99, 31, v99
    v_and_b32 v99, 0xf149f2ca, v99
    v_subrev_u32 v100, 17, v26
    v_ashrrev_i32 v100, 31, v100
    v_and_b32 v100, 0xf149f2ca, v100
    v_subrev_u32 v101, 21, v26
    v_ashrrev_i32 v101, 31, v101
    v_and_b32 v101, 0xf149f2ca, v101
    v_subrev_u32 v102, 25, v26
    v_ashrrev_i32 v102, 31, v102
    v_and_b32 v102, 0xf149f2ca, v102
    v_subrev_u32 v103, 29, v26
    v_ashrrev_i32 v103, 31, v103
    v_and_b32 v103, 0xf149f2ca, v103
    v_subrev_u32 v104, 33, v26
    v_ashrrev_i32 v104, 31, v104
    v_and_b32 v104, 0xf149f2ca, v104
    v_subrev_u32 v105, 37, v26
    v_ashrrev_i32 v105, 31, v105
    v_and_b32 v105, 0xf149f2ca, v105
    v_subrev_u32 v106, 41, v26
    v_ashrrev_i32 v106, 31, v106
    v_and_b32 v106, 0xf149f2ca, v106
    v_subrev_u32 v107, 45, v26
    v_ashrrev_i32 v107, 31, v107
    v_and_b32 v107, 0xf149f2ca, v107
    v_subrev_u32 v108, 49, v26
    v_ashrrev_i32 v108, 31, v108
    v_and_b32 v108, 0xf149f2ca, v108
    v_subrev_u32 v109, 53, v26
    v_ashrrev_i32 v109, 31, v109
    v_and_b32 v109, 0xf149f2ca, v109
    v_subrev_u32 v110, 57, v26
    v_ashrrev_i32 v110, 31, v110
    v_and_b32 v110, 0xf149f2ca, v110
    v_subrev_u32 v111, 61, v26
    v_ashrrev_i32 v111, 31, v111
    v_and_b32 v111, 0xf149f2ca, v111
    v_subrev_u32 v112, 65, v26
    v_ashrrev_i32 v112, 31, v112
    v_and_b32 v112, 0xf149f2ca, v112
    v_subrev_u32 v113, 69, v26
    v_ashrrev_i32 v113, 31, v113
    v_and_b32 v113, 0xf149f2ca, v113
    v_subrev_u32 v114, 73, v26
    v_ashrrev_i32 v114, 31, v114
    v_and_b32 v114, 0xf149f2ca, v114
    v_subrev_u32 v115, 77, v26
    v_ashrrev_i32 v115, 31, v115
    v_and_b32 v115, 0xf149f2ca, v115
    v_subrev_u32 v116, 81, v26
    v_ashrrev_i32 v116, 31, v116
    v_and_b32 v116, 0xf149f2ca, v116
    v_subrev_u32 v117, 85, v26
    v_ashrrev_i32 v117, 31, v117
    v_and_b32 v117, 0xf149f2ca, v117
    v_subrev_u32 v118, 89, v26
    v_ashrrev_i32 v118, 31, v118
    v_and_b32 v118, 0xf149f2ca, v118
    v_subrev_u32 v119, 93, v26
    v_ashrrev_i32 v119, 31, v119
    v_and_b32 v119, 0xf149f2ca, v119
    v_subrev_u32 v128, 1, v27
    v_ashrrev_i32 v128, 31, v128
    v_and_b32 v128, 0xf149f2ca, v128
    v_subrev_u32 v129, 5, v27
    v_ashrrev_i32 v129, 31, v129
    v_and_b32 v129, 0xf149f2ca, v129
    v_subrev_u32 v130, 9, v27
    v_ashrrev_i32 v130, 31, v130
    v_and_b32 v130, 0xf149f2ca, v130
    v_subrev_u32 v131, 13, v27
    v_ashrrev_i32 v131, 31, v131
    v_and_b32 v131, 0xf149f2ca, v131
    v_subrev_u32 v132, 17, v27
    v_ashrrev_i32 v132, 31, v132
    v_and_b32 v132, 0xf149f2ca, v132
    v_subrev_u32 v133, 21, v27
    v_ashrrev_i32 v133, 31, v133
    v_and_b32 v133, 0xf149f2ca, v133
    v_subrev_u32 v134, 25, v27
    v_ashrrev_i32 v134, 31, v134
    v_and_b32 v134, 0xf149f2ca, v134
    v_subrev_u32 v135, 29, v27
    v_ashrrev_i32 v135, 31, v135
    v_and_b32 v135, 0xf149f2ca, v135
    v_subrev_u32 v136, 33, v27
    v_ashrrev_i32 v136, 31, v136
    v_and_b32 v136, 0xf149f2ca, v136
    v_subrev_u32 v137, 37, v27
    v_ashrrev_i32 v137, 31, v137
    v_and_b32 v137, 0xf149f2ca, v137
    v_subrev_u32 v138, 41, v27
    v_ashrrev_i32 v138, 31, v138
    v_and_b32 v138, 0xf149f2ca, v138
    v_subrev_u32 v139, 45, v27
    v_ashrrev_i32 v139, 31, v139
    v_and_b32 v139, 0xf149f2ca, v139
    v_subrev_u32 v140, 49, v27
    v_ashrrev_i32 v140, 31, v140
    v_and_b32 v140, 0xf149f2ca, v140
    v_subrev_u32 v141, 53, v27
    v_ashrrev_i32 v141, 31, v141
    v_and_b32 v141, 0xf149f2ca, v141
    v_subrev_u32 v142, 57, v27
    v_ashrrev_i32 v142, 31, v142
    v_and_b32 v142, 0xf149f2ca, v142
    v_subrev_u32 v143, 61, v27
    v_ashrrev_i32 v143, 31, v143
    v_and_b32 v143, 0xf149f2ca, v143
    v_subrev_u32 v144, 65, v27
    v_ashrrev_i32 v144, 31, v144
    v_and_b32 v144, 0xf149f2ca, v144
    v_subrev_u32 v145, 69, v27
    v_ashrrev_i32 v145, 31, v145
    v_and_b32 v145, 0xf149f2ca, v145
    v_subrev_u32 v146, 73, v27
    v_ashrrev_i32 v146, 31, v146
    v_and_b32 v146, 0xf149f2ca, v146
    v_subrev_u32 v147, 77, v27
    v_ashrrev_i32 v147, 31, v147
    v_and_b32 v147, 0xf149f2ca, v147
    v_subrev_u32 v148, 81, v27
    v_ashrrev_i32 v148, 31, v148
    v_and_b32 v148, 0xf149f2ca, v148
    v_subrev_u32 v149, 85, v27
    v_ashrrev_i32 v149, 31, v149
    v_and_b32 v149, 0xf149f2ca, v149
    v_subrev_u32 v150, 89, v27
    v_ashrrev_i32 v150, 31, v150
    v_and_b32 v150, 0xf149f2ca, v150
    v_subrev_u32 v151, 93, v27
    v_ashrrev_i32 v151, 31, v151
    v_and_b32 v151, 0xf149f2ca, v151
    v_min_i32 v6, v28, v29
    v_cmp_ge_i32 vcc, 0, v6
    s_cbranch_vccz L_S_qok
    v_cmp_lt_i32 vcc, 0, v28
    s_nop 1
    v_cndmask_b32 v32, 0, v32, vcc
    v_cndmask_b32 v33, 0, v33, vcc
    v_cndmask_b32 v34, 0, v34, vcc
    v_cndmask_b32 v35, 0, v35, vcc
    v_cndmask_b32 v36, 0, v36, vcc
    v_cndmask_b32 v37, 0, v37, vcc
    v_cndmask_b32 v38, 0, v38, vcc
    v_cndmask_b32 v39, 0, v39, vcc
    v_cndmask_b32 v40, 0, v40, vcc
    v_cndmask_b32 v41, 0, v41, vcc
    v_cndmask_b32 v42, 0, v42, vcc
    v_cndmask_b32 v43, 0, v43, vcc
    v_cndmask_b32 v44, 0, v44, vcc
    v_cndmask_b32 v45, 0, v45, vcc
    v_cndmask_b32 v46, 0, v46, vcc
    v_cndmask_b32 v47, 0, v47, vcc
    v_cmp_lt_i32 vcc, 0, v29
    s_nop 1
    v_cndmask_b32 v48, 0, v48, vcc
    v_cndmask_b32 v49, 0, v49, vcc
    v_cndmask_b32 v50, 0, v50, vcc
    v_cndmask_b32 v51, 0, v51, vcc
    v_cndmask_b32 v52, 0, v52, vcc
    v_cndmask_b32 v53, 0, v53, vcc
    v_cndmask_b32 v54, 0, v54, vcc
    v_cndmask_b32 v55, 0, v55, vcc
    v_cndmask_b32 v56, 0, v56, vcc
    v_cndmask_b32 v57, 0, v57, vcc
    v_cndmask_b32 v58, 0, v58, vcc
    v_cndmask_b32 v59, 0, v59, vcc
    v_cndmask_b32 v60, 0, v60, vcc
    v_cndmask_b32 v61, 0, v61, vcc
    v_cndmask_b32 v62, 0, v62, vcc
    v_cndmask_b32 v63, 0, v63, vcc
    s_nop 1
L_S_qok:
    ds_read_b128 v[64:67], v16 offset:0
    ds_read_b128 v[68:71], v17 offset:0
    ds_read_b128 v[72:75], v18 offset:0
    ds_read_b128 v[76:79], v19 offset:0
    s_waitcnt lgkmcnt(0)
    s_add_u32 m0, s96, 0
    v_subrev_u32 v6, 65, v4
    v_and_or_b32 v6, v6, s95, v12
    buffer_load_dwordx4 v6, s[20:23], s68 offen sc0 sc1 nt lds
    s_add_u32 m0, s96, 1024
    v_subrev_u32 v7, 69, v4
    v_and_or_b32 v7, v7, s95, v13
    buffer_load_dwordx4 v7, s[20:23], s69 offen sc0 sc1 nt lds
    s_add_u32 m0, s96, 2048
    v_subrev_u32 v6, 73, v4
    v_and_or_b32 v6, v6, s95, v14
    buffer_load_dwordx4 v6, s[20:23], s70 offen sc0 sc1 nt lds
    s_add_u32 m0, s96, 3072
    v_subrev_u32 v7, 77, v4
    v_and_or_b32 v7, v7, s95, v15
    buffer_load_dwordx4 v7, s[20:23], s71 offen sc0 sc1 nt lds
    v_mfma_f32_16x16x32_bf16 v[96:99], v[64:67], v[32:35], v[96:99]
    v_mfma_f32_16x16x32_bf16 v[128:131], v[64:67], v[48:51], v[128:131]
    v_mfma_f32_16x16x32_bf16 v[96:99], v[68:71], v[36:39], v[96:99]
    v_mfma_f32_16x16x32_bf16 v[128:131], v[68:71], v[52:55], v[128:131]
    v_mfma_f32_16x16x32_bf16 v[96:99], v[72:75], v[40:43], v[96:99]
    v_mfma_f32_16x16x32_bf16 v[128:131], v[72:75], v[56:59], v[128:131]
    v_mfma_f32_16x16x32_bf16 v[96:99], v[76:79], v[44:47], v[96:99]
    v_mfma_f32_16x16x32_bf16 v[128:131], v[76:79], v[60:63], v[128:131]
    ds_read_b128 v[80:83], v16 offset:4096
    ds_read_b128 v[84:87], v17 offset:4096
    ds_read_b128 v[88:91], v18 offset:4096
    ds_read_b128 v[92:95], v19 offset:4096
    s_waitcnt lgkmcnt(0)
    s_add_u32 m0, s96, 4096
    v_subrev_u32 v6, 81, v4
    v_and_or_b32 v6, v6, s95, v12
    buffer_load_dwordx4 v6, s[20:23], s72 offen sc0 sc1 nt lds
    s_add_u32 m0, s96, 5120
    v_subrev_u32 v7, 85, v4
    v_and_or_b32 v7, v7, s95, v13
    buffer_load_dwordx4 v7, s[20:23], s73 offen sc0 sc1 nt lds
    s_add_u32 m0, s96, 6144
    v_subrev_u32 v6, 89, v4
    v_and_or_b32 v6, v6, s95, v14
    buffer_load_dwordx4 v6, s[20:23], s74 offen sc0 sc1 nt lds
    s_add_u32 m0, s96, 7168
    v_subrev_u32 v7, 93, v4
    v_and_or_b32 v7, v7, s95, v15
    buffer_load_dwordx4 v7, s[20:23], s75 offen sc0 sc1 nt lds
    v_mfma_f32_16x16x32_bf16 v[100:103], v[80:83], v[32:35], v[100:103]
    v_mfma_f32_16x16x32_bf16 v[132:135], v[80:83], v[48:51], v[132:135]
    v_mfma_f32_16x16x32_bf16 v[100:103], v[84:87], v[36:39], v[100:103]
    v_mfma_f32_16x16x32_bf16 v[132:135], v[84:87], v[52:55], v[132:135]
    v_mfma_f32_16x16x32_bf16 v[100:103], v[88:91], v[40:43], v[100:103]
    v_mfma_f32_16x16x32_bf16 v[132:135], v[88:91], v[56:59], v[132:135]
    v_mfma_f32_16x16x32_bf16 v[100:103], v[92:95], v[44:47], v[100:103]
    v_mfma_f32_16x16x32_bf16 v[132:135], v[92:95], v[60:63], v[132:135]
    s_waitcnt vmcnt(12)
    ds_read_b128 v[64:67], v16 offset:8192
    ds_read_b128 v[68:71], v17 offset:8192
    ds_read_b128 v[72:75], v18 offset:8192
    ds_read_b128 v[76:79], v19 offset:8192
    v_subrev_u32 v6, 1, v4
    v_and_or_b32 v6, v6, s95, v8
    buffer_load_dwordx4 v[160:163], v6, s[24:27], s52 offen sc0 sc1 nt
    v_subrev_u32 v7, 5, v4
    v_and_or_b32 v7, v7, s95, v8
    buffer_load_dwordx4 v[164:167], v7, s[24:27], s53 offen sc0 sc1 nt
    v_subrev_u32 v6, 9, v4
    v_and_or_b32 v6, v6, s95, v8
    buffer_load_dwordx4 v[168:171], v6, s[24:27], s54 offen sc0 sc1 nt
    v_subrev_u32 v7, 13, v4
    v_and_or_b32 v7, v7, s95, v8
    buffer_load_dwordx4 v[172:175], v7, s[24:27], s55 offen sc0 sc1 nt
    s_waitcnt lgkmcnt(0)
    v_mfma_f32_16x16x32_bf16 v[104:107], v[64:67], v[32:35], v[104:107]
    v_mfma_f32_16x16x32_bf16 v[136:139], v[64:67], v[48:51], v[136:139]
    v_mfma_f32_16x16x32_bf16 v[104:107], v[68:71], v[36:39], v[104:107]
    v_mfma_f32_16x16x32_bf16 v[136:139], v[68:71], v[52:55], v[136:139]
    v_mfma_f32_16x16x32_bf16 v[104:107], v[72:75], v[40:43], v[104:107]
    v_mfma_f32_16x16x32_bf16 v[136:139], v[72:75], v[56:59], v[136:139]
    v_mfma_f32_16x16x32_bf16 v[104:107], v[76:79], v[44:47], v[104:107]
    v_mfma_f32_16x16x32_bf16 v[136:139], v[76:79], v[60:63], v[136:139]
    s_waitcnt vmcnt(12)
    ds_read_b128 v[80:83], v16 offset:12288
    ds_read_b128 v[84:87], v17 offset:12288
    ds_read_b128 v[88:91], v18 offset:12288
    ds_read_b128 v[92:95], v19 offset:12288
    v_subrev_u32 v6, 17, v4
    v_and_or_b32 v6, v6, s95, v8
    buffer_load_dwordx4 v[176:179], v6, s[24:27], s56 offen sc0 sc1 nt
    v_subrev_u32 v7, 21, v4
    v_and_or_b32 v7, v7, s95, v8
    buffer_load_dwordx4 v[180:183], v7, s[24:27], s57 offen sc0 sc1 nt
    v_subrev_u32 v6, 25, v4
    v_and_or_b32 v6, v6, s95, v8
    buffer_load_dwordx4 v[184:187], v6, s[24:27], s58 offen sc0 sc1 nt
    v_subrev_u32 v7, 29, v4
    v_and_or_b32 v7, v7, s95, v8
    buffer_load_dwordx4 v[188:191], v7, s[24:27], s59 offen sc0 sc1 nt
    s_waitcnt lgkmcnt(0)
    v_mfma_f32_16x16x32_bf16 v[108:111], v[80:83], v[32:35], v[108:111]
    v_mfma_f32_16x16x32_bf16 v[140:143], v[80:83], v[48:51], v[140:143]
    v_mfma_f32_16x16x32_bf16 v[108:111], v[84:87], v[36:39], v[108:111]
    v_mfma_f32_16x16x32_bf16 v[140:143], v[84:87], v[52:55], v[140:143]
    v_mfma_f32_16x16x32_bf16 v[108:111], v[88:91], v[40:43], v[108:111]
    v_mfma_f32_16x16x32_bf16 v[140:143], v[88:91], v[56:59], v[140:143]
    v_mfma_f32_16x16x32_bf16 v[108:111], v[92:95], v[44:47], v[108:111]
    v_mfma_f32_16x16x32_bf16 v[140:143], v[92:95], v[60:63], v[140:143]
    s_waitcnt vmcnt(12)
    ds_read_b128 v[64:67], v16 offset:0
    ds_read_b128 v[68:71], v17 offset:0
    ds_read_b128 v[72:75], v18 offset:0
    ds_read_b128 v[76:79], v19 offset:0
    v_subrev_u32 v6, 33, v4
    v_and_or_b32 v6, v6, s95, v8
    buffer_load_dwordx4 v[192:195], v6, s[24:27], s60 offen sc0 sc1 nt
    v_subrev_u32 v7, 37, v4
    v_and_or_b32 v7, v7, s95, v8
    buffer_load_dwordx4 v[196:199], v7, s[24:27], s61 offen sc0 sc1 nt
    v_subrev_u32 v6, 41, v4
    v_and_or_b32 v6, v6, s95, v8
    buffer_load_dwordx4 v[200:203], v6, s[24:27], s62 offen sc0 sc1 nt
    v_subrev_u32 v7, 45, v4
    v_and_or_b32 v7, v7, s95, v8
    buffer_load_dwordx4 v[204:207], v7, s[24:27], s63 offen sc0 sc1 nt
    s_waitcnt lgkmcnt(0)
    v_mfma_f32_16x16x32_bf16 v[112:115], v[64:67], v[32:35], v[112:115]
    v_mfma_f32_16x16x32_bf16 v[144:147], v[64:67], v[48:51], v[144:147]
    v_mfma_f32_16x16x32_bf16 v[112:115], v[68:71], v[36:39], v[112:115]
    v_mfma_f32_16x16x32_bf16 v[144:147], v[68:71], v[52:55], v[144:147]
    v_mfma_f32_16x16x32_bf16 v[112:115], v[72:75], v[40:43], v[112:115]
    v_mfma_f32_16x16x32_bf16 v[144:147], v[72:75], v[56:59], v[144:147]
    v_mfma_f32_16x16x32_bf16 v[112:115], v[76:79], v[44:47], v[112:115]
    v_mfma_f32_16x16x32_bf16 v[144:147], v[76:79], v[60:63], v[144:147]
    s_waitcnt vmcnt(12)
    ds_read_b128 v[80:83], v16 offset:4096
    ds_read_b128 v[84:87], v17 offset:4096
    ds_read_b128 v[88:91], v18 offset:4096
    ds_read_b128 v[92:95], v19 offset:4096
    v_subrev_u32 v6, 49, v4
    v_and_or_b32 v6, v6, s95, v8
    buffer_load_dwordx4 v[208:211], v6, s[24:27], s64 offen sc0 sc1 nt
    v_subrev_u32 v7, 53, v4
    v_and_or_b32 v7, v7, s95, v8
    buffer_load_dwordx4 v[212:215], v7, s[24:27], s65 offen sc0 sc1 nt
    v_subrev_u32 v6, 57, v4
    v_and_or_b32 v6, v6, s95, v8
    buffer_load_dwordx4 v[216:219], v6, s[24:27], s66 offen sc0 sc1 nt
    v_subrev_u32 v7, 61, v4
    v_and_or_b32 v7, v7, s95, v8
    buffer_load_dwordx4 v[220:223], v7, s[24:27], s67 offen sc0 sc1 nt
    s_waitcnt lgkmcnt(0)
    v_mfma_f32_16x16x32_bf16 v[116:119], v[80:83], v[32:35], v[116:119]
    v_mfma_f32_16x16x32_bf16 v[148:151], v[80:83], v[48:51], v[148:151]
    v_mfma_f32_16x16x32_bf16 v[116:119], v[84:87], v[36:39], v[116:119]
    v_mfma_f32_16x16x32_bf16 v[148:151], v[84:87], v[52:55], v[148:151]
    v_mfma_f32_16x16x32_bf16 v[116:119], v[88:91], v[40:43], v[116:119]
    v_mfma_f32_16x16x32_bf16 v[148:151], v[88:91], v[56:59], v[148:151]
    v_mfma_f32_16x16x32_bf16 v[116:119], v[92:95], v[44:47], v[116:119]
    v_mfma_f32_16x16x32_bf16 v[148:151], v[92:95], v[60:63], v[148:151]
    s_nop 7
    v_max3_f32 v20, v96, v97, v98
    v_max3_f32 v20, v20, v99, v100
    v_max3_f32 v20, v20, v101, v102
    v_max3_f32 v20, v20, v103, v104
    v_max3_f32 v20, v20, v105, v106
    v_max3_f32 v20, v20, v107, v108
    v_max3_f32 v20, v20, v109, v110
    v_max3_f32 v20, v20, v111, v112
    v_max3_f32 v20, v20, v113, v114
    v_max3_f32 v20, v20, v115, v116
    v_max3_f32 v20, v20, v117, v118
    v_max_f32 v20, v20, v119
    v_mov_b32 v24, v20
    s_nop 1
    v_permlane16_swap_b32 v24, v20
    v_max_f32 v20, v20, v24
    v_mov_b32 v24, v20
    s_nop 1
    v_permlane32_swap_b32 v24, v20
    v_max_f32 v20, v20, v24
    v_max3_f32 v22, v128, v129, v130
    v_max3_f32 v22, v22, v131, v132
    v_max3_f32 v22, v22, v133, v134
    v_max3_f32 v22, v22, v135, v136
    v_max3_f32 v22, v22, v137, v138
    v_max3_f32 v22, v22, v139, v140
    v_max3_f32 v22, v22, v141, v142
    v_max3_f32 v22, v22, v143, v144
    v_max3_f32 v22, v22, v145, v146
    v_max3_f32 v22, v22, v147, v148
    v_max3_f32 v22, v22, v149, v150
    v_max_f32 v22, v22, v151
    v_mov_b32 v24, v22
    s_nop 1
    v_permlane16_swap_b32 v24, v22
    v_max_f32 v22, v22, v24
    v_mov_b32 v24, v22
    s_nop 1
    v_permlane32_swap_b32 v24, v22
    v_max_f32 v22, v22, v24
    v_subrev_u32 v6, 65, v4
    v_and_or_b32 v6, v6, s95, v8
    buffer_load_dwordx4 v[224:227], v6, s[24:27], s68 offen sc0 sc1 nt
    v_subrev_u32 v7, 69, v4
    v_and_or_b32 v7, v7, s95, v8
    buffer_load_dwordx4 v[228:231], v7, s[24:27], s69 offen sc0 sc1 nt
    v_subrev_u32 v6, 73, v4
    v_and_or_b32 v6, v6, s95, v8
    buffer_load_dwordx4 v[232:235], v6, s[24:27], s70 offen sc0 sc1 nt
    v_subrev_u32 v7, 77, v4
    v_and_or_b32 v7, v7, s95, v8
    buffer_load_dwordx4 v[236:239], v7, s[24:27], s71 offen sc0 sc1 nt
    v_pk_add_f32 v[96:97], v[96:97], v[20:21] op_sel_hi:[1,0] neg_lo:[0,1] neg_hi:[0,1]
    v_pk_add_f32 v[98:99], v[98:99], v[20:21] op_sel_hi:[1,0] neg_lo:[0,1] neg_hi:[0,1]
    v_pk_add_f32 v[100:101], v[100:101], v[20:21] op_sel_hi:[1,0] neg_lo:[0,1] neg_hi:[0,1]
    v_pk_add_f32 v[102:103], v[102:103], v[20:21] op_sel_hi:[1,0] neg_lo:[0,1] neg_hi:[0,1]
    v_pk_add_f32 v[104:105], v[104:105], v[20:21] op_sel_hi:[1,0] neg_lo:[0,1] neg_hi:[0,1]
    v_pk_add_f32 v[106:107], v[106:107], v[20:21] op_sel_hi:[1,0] neg_lo:[0,1] neg_hi:[0,1]
    v_pk_add_f32 v[108:109], v[108:109], v[20:21] op_sel_hi:[1,0] neg_lo:[0,1] neg_hi:[0,1]
    v_pk_add_f32 v[110:111], v[110:111], v[20:21] op_sel_hi:[1,0] neg_lo:[0,1] neg_hi:[0,1]
    v_pk_add_f32 v[112:113], v[112:113], v[20:21] op_sel_hi:[1,0] neg_lo:[0,1] neg_hi:[0,1]
    v_pk_add_f32 v[114:115], v[114:115], v[20:21] op_sel_hi:[1,0] neg_lo:[0,1] neg_hi:[0,1]
    v_pk_add_f32 v[116:117], v[116:117], v[20:21] op_sel_hi:[1,0] neg_lo:[0,1] neg_hi:[0,1]
    v_pk_add_f32 v[118:119], v[118:119], v[20:21] op_sel_hi:[1,0] neg_lo:[0,1] neg_hi:[0,1]
    v_pk_mul_f32 v[96:97], v[96:97], s[92:93] op_sel_hi:[1,0]
    v_pk_mul_f32 v[98:99], v[98:99], s[92:93] op_sel_hi:[1,0]
    v_pk_mul_f32 v[100:101], v[100:101], s[92:93] op_sel_hi:[1,0]
    v_pk_mul_f32 v[102:103], v[102:103], s[92:93] op_sel_hi:[1,0]
    v_pk_mul_f32 v[104:105], v[104:105], s[92:93] op_sel_hi:[1,0]
    v_pk_mul_f32 v[106:107], v[106:107], s[92:93] op_sel_hi:[1,0]
    v_pk_mul_f32 v[108:109], v[108:109], s[92:93] op_sel_hi:[1,0]
    v_pk_mul_f32 v[110:111], v[110:111], s[92:93] op_sel_hi:[1,0]
    v_pk_mul_f32 v[112:113], v[112:113], s[92:93] op_sel_hi:[1,0]
    v_pk_mul_f32 v[114:115], v[114:115], s[92:93] op_sel_hi:[1,0]
    v_pk_mul_f32 v[116:117], v[116:117], s[92:93] op_sel_hi:[1,0]
    v_pk_mul_f32 v[118:119], v[118:119], s[92:93] op_sel_hi:[1,0]
    v_exp_f32 v96, v96
    v_exp_f32 v97, v97
    v_exp_f32 v98, v98
    v_exp_f32 v99, v99
    v_exp_f32 v100, v100
    v_exp_f32 v101, v101
    v_exp_f32 v102, v102
    v_exp_f32 v103, v103
    v_exp_f32 v104, v104
    v_exp_f32 v105, v105
    v_exp_f32 v106, v106
    v_exp_f32 v107, v107
    v_exp_f32 v108, v108
    v_exp_f32 v109, v109
    v_exp_f32 v110, v110
    v_exp_f32 v111, v111
    v_exp_f32 v112, v112
    v_exp_f32 v113, v113
    v_exp_f32 v114, v114
    v_exp_f32 v115, v115
    v_exp_f32 v116, v116
    v_exp_f32 v117, v117
    v_exp_f32 v118, v118
    v_exp_f32 v119, v119
    s_nop 0
    v_pk_add_f32 v[24:25], v[96:97], v[98:99]
    v_pk_add_f32 v[24:25], v[24:25], v[100:101]
    v_pk_add_f32 v[24:25], v[24:25], v[102:103]
    v_pk_add_f32 v[24:25], v[24:25], v[104:105]
    v_pk_add_f32 v[24:25], v[24:25], v[106:107]
    v_pk_add_f32 v[24:25], v[24:25], v[108:109]
    v_pk_add_f32 v[24:25], v[24:25], v[110:111]
    v_pk_add_f32 v[24:25], v[24:25], v[112:113]
    v_pk_add_f32 v[24:25], v[24:25], v[114:115]
    v_pk_add_f32 v[24:25], v[24:25], v[116:117]
    v_pk_add_f32 v[24:25], v[24:25], v[118:119]
    v_add_f32 v21, v24, v25
    v_cvt_pk_bf16_f32 v96, v96, v97
    v_cvt_pk_bf16_f32 v97, v98, v99
    v_cvt_pk_bf16_f32 v98, v100, v101
    v_cvt_pk_bf16_f32 v99, v102, v103
    v_cvt_pk_bf16_f32 v104, v104, v105
    v_cvt_pk_bf16_f32 v105, v106, v107
    v_cvt_pk_bf16_f32 v106, v108, v109
    v_cvt_pk_bf16_f32 v107, v110, v111
    v_cvt_pk_bf16_f32 v112, v112, v113
    v_cvt_pk_bf16_f32 v113, v114, v115
    v_cvt_pk_bf16_f32 v114, v116, v117
    v_cvt_pk_bf16_f32 v115, v118, v119
    v_mov_b32 v24, v21
    s_nop 1
    v_permlane16_swap_b32 v24, v21
    v_add_f32 v21, v21, v24
    v_mov_b32 v24, v21
    s_nop 1
    v_permlane32_swap_b32 v24, v21
    v_add_f32 v21, v21, v24
    v_subrev_u32 v6, 81, v4
    v_and_or_b32 v6, v6, s95, v8
    buffer_load_dwordx4 v[240:243], v6, s[24:27], s72 offen sc0 sc1 nt
    v_subrev_u32 v7, 85, v4
    v_and_or_b32 v7, v7, s95, v8
    buffer_load_dwordx4 v[244:247], v7, s[24:27], s73 offen sc0 sc1 nt
    v_subrev_u32 v6, 89, v4
    v_and_or_b32 v6, v6, s95, v8
    buffer_load_dwordx4 v[248:251], v6, s[24:27], s74 offen sc0 sc1 nt
    v_subrev_u32 v7, 93, v4
    v_and_or_b32 v7, v7, s95, v8
    buffer_load_dwordx4 v[252:255], v7, s[24:27], s75 offen sc0 sc1 nt
    v_pk_add_f32 v[128:129], v[128:129], v[22:23] op_sel_hi:[1,0] neg_lo:[0,1] neg_hi:[0,1]
    v_pk_add_f32 v[130:131], v[130:131], v[22:23] op_sel_hi:[1,0] neg_lo:[0,1] neg_hi:[0,1]
    v_pk_add_f32 v[132:133], v[132:133], v[22:23] op_sel_hi:[1,0] neg_lo:[0,1] neg_hi:[0,1]
    v_pk_add_f32 v[134:135], v[134:135], v[22:23] op_sel_hi:[1,0] neg_lo:[0,1] neg_hi:[0,1]
    v_pk_add_f32 v[136:137], v[136:137], v[22:23] op_sel_hi:[1,0] neg_lo:[0,1] neg_hi:[0,1]
    v_pk_add_f32 v[138:139], v[138:139], v[22:23] op_sel_hi:[1,0] neg_lo:[0,1] neg_hi:[0,1]
    v_pk_add_f32 v[140:141], v[140:141], v[22:23] op_sel_hi:[1,0] neg_lo:[0,1] neg_hi:[0,1]
    v_pk_add_f32 v[142:143], v[142:143], v[22:23] op_sel_hi:[1,0] neg_lo:[0,1] neg_hi:[0,1]
    v_pk_add_f32 v[144:145], v[144:145], v[22:23] op_sel_hi:[1,0] neg_lo:[0,1] neg_hi:[0,1]
    v_pk_add_f32 v[146:147], v[146:147], v[22:23] op_sel_hi:[1,0] neg_lo:[0,1] neg_hi:[0,1]
    v_pk_add_f32 v[148:149], v[148:149], v[22:23] op_sel_hi:[1,0] neg_lo:[0,1] neg_hi:[0,1]
    v_pk_add_f32 v[150:151], v[150:151], v[22:23] op_sel_hi:[1,0] neg_lo:[0,1] neg_hi:[0,1]
    v_pk_mul_f32 v[128:129], v[128:129], s[92:93] op_sel_hi:[1,0]
    v_pk_mul_f32 v[130:131], v[130:131], s[92:93] op_sel_hi:[1,0]
    v_pk_mul_f32 v[132:133], v[132:133], s[92:93] op_sel_hi:[1,0]
    v_pk_mul_f32 v[134:135], v[134:135], s[92:93] op_sel_hi:[1,0]
    v_pk_mul_f32 v[136:137], v[136:137], s[92:93] op_sel_hi:[1,0]
    v_pk_mul_f32 v[138:139], v[138:139], s[92:93] op_sel_hi:[1,0]
    v_pk_mul_f32 v[140:141], v[140:141], s[92:93] op_sel_hi:[1,0]
    v_pk_mul_f32 v[142:143], v[142:143], s[92:93] op_sel_hi:[1,0]
    v_pk_mul_f32 v[144:145], v[144:145], s[92:93] op_sel_hi:[1,0]
    v_pk_mul_f32 v[146:147], v[146:147], s[92:93] op_sel_hi:[1,0]
    v_pk_mul_f32 v[148:149], v[148:149], s[92:93] op_sel_hi:[1,0]
    v_pk_mul_f32 v[150:151], v[150:151], s[92:93] op_sel_hi:[1,0]
    v_exp_f32 v128, v128
    v_exp_f32 v129, v129
    v_exp_f32 v130, v130
    v_exp_f32 v131, v131
    v_exp_f32 v132, v132
    v_exp_f32 v133, v133
    v_exp_f32 v134, v134
    v_exp_f32 v135, v135
    v_exp_f32 v136, v136
    v_exp_f32 v137, v137
    v_exp_f32 v138, v138
    v_exp_f32 v139, v139
    v_exp_f32 v140, v140
    v_exp_f32 v141, v141
    v_exp_f32 v142, v142
    v_exp_f32 v143, v143
    v_exp_f32 v144, v144
    v_exp_f32 v145, v145
    v_exp_f32 v146, v146
    v_exp_f32 v147, v147
    v_exp_f32 v148, v148
    v_exp_f32 v149, v149
    v_exp_f32 v150, v150
    v_exp_f32 v151, v151
    s_nop 0
    v_pk_add_f32 v[24:25], v[128:129], v[130:131]
    v_pk_add_f32 v[24:25], v[24:25], v[132:133]
    v_pk_add_f32 v[24:25], v[24:25], v[134:135]
    v_pk_add_f32 v[24:25], v[24:25], v[136:137]
    v_pk_add_f32 v[24:25], v[24:25], v[138:139]
    v_pk_add_f32 v[24:25], v[24:25], v[140:141]
    v_pk_add_f32 v[24:25], v[24:25], v[142:143]
    v_pk_add_f32 v[24:25], v[24:25], v[144:145]
    v_pk_add_f32 v[24:25], v[24:25], v[146:147]
    v_pk_add_f32 v[24:25], v[24:25], v[148:149]
    v_pk_add_f32 v[24:25], v[24:25], v[150:151]
    v_add_f32 v23, v24, v25
    v_cvt_pk_bf16_f32 v128, v128, v129
    v_cvt_pk_bf16_f32 v129, v130, v131
    v_cvt_pk_bf16_f32 v130, v132, v133
    v_cvt_pk_bf16_f32 v131, v134, v135
    v_cvt_pk_bf16_f32 v136, v136, v137
    v_cvt_pk_bf16_f32 v137, v138, v139
    v_cvt_pk_bf16_f32 v138, v140, v141
    v_cvt_pk_bf16_f32 v139, v142, v143
    v_cvt_pk_bf16_f32 v144, v144, v145
    v_cvt_pk_bf16_f32 v145, v146, v147
    v_cvt_pk_bf16_f32 v146, v148, v149
    v_cvt_pk_bf16_f32 v147, v150, v151
    v_mov_b32 v24, v23
    s_nop 1
    v_permlane16_swap_b32 v24, v23
    v_add_f32 v23, v23, v24
    v_mov_b32 v24, v23
    s_nop 1
    v_permlane32_swap_b32 v24, v23
    v_add_f32 v23, v23, v24
    s_and_b32 s90, s84, 3
    s_lshl_b32 s91, s90, 4
    s_lshl_b64 s[76:77], 0xffff, s91
    s_lshl_b32 s91, s90, 2
    s_lshl_b32 s78, 15, s91
    s_lshr_b32 s90, s84, 2
    s_add_u32 s90, s90, 1
    s_cmp_lg_u32 s51, 0
    s_cselect_b64 s[76:77], -1, s[76:77]
    s_cselect_b32 s78, 0xffff, s78
    s_cselect_b32 s79, 3, s90
    s_cmp_ge_u32 s89, 4
    s_cselect_b32 s79, s79, 0
    s_mul_i32 s80, s0, 192
    s_add_u32 s80, s80, s85
    s_lshl_b32 s80, s80, 8
    s_mul_i32 s90, s0, 22
    s_add_u32 s90, s90, s85
    s_lshl_b32 s90, s90, 8
    s_add_u32 s90, s90, 3145728
    s_add_u32 s91, s90, 128
    v_mul_u32_u24 v24, 393216, v2
    v_lshl_add_u32 v24, v3, 4, v24
    v_lshlrev_b32 v25, 3, v3
    s_bitcmp1_b32 s79, 0
    s_cselect_b32 s90, s90, s95
    s_bitcmp1_b32 s79, 1
    s_cselect_b32 s91, s91, s95
    s_mov_b32 s81, s90
    s_mov_b32 s82, s91
    s_waitcnt vmcnt(16)
    v_perm_b32 v100, v164, v160, s93
    v_perm_b32 v101, v172, v168, s93
    v_perm_b32 v102, v180, v176, s93
    v_perm_b32 v103, v188, v184, s93
    v_perm_b32 v108, v164, v160, s94
    v_perm_b32 v109, v172, v168, s94
    v_perm_b32 v110, v180, v176, s94
    v_perm_b32 v111, v188, v184, s94
    v_mfma_f32_16x16x32_bf16 v[32:35], v[96:99], v[100:103], 0
    v_mfma_f32_16x16x32_bf16 v[64:67], v[128:131], v[100:103], 0
    v_perm_b32 v132, v165, v161, s93
    v_perm_b32 v133, v173, v169, s93
    v_perm_b32 v134, v181, v177, s93
    v_perm_b32 v135, v189, v185, s93
    v_mfma_f32_16x16x32_bf16 v[36:39], v[96:99], v[108:111], 0
    v_mfma_f32_16x16x32_bf16 v[68:71], v[128:131], v[108:111], 0
    v_perm_b32 v140, v165, v161, s94
    v_perm_b32 v141, v173, v169, s94
    v_perm_b32 v142, v181, v177, s94
    v_perm_b32 v143, v189, v185, s94
    v_mfma_f32_16x16x32_bf16 v[40:43], v[96:99], v[132:135], 0
    v_mfma_f32_16x16x32_bf16 v[72:75], v[128:131], v[132:135], 0
    v_perm_b32 v100, v166, v162, s93
    v_perm_b32 v101, v174, v170, s93
    v_perm_b32 v102, v182, v178, s93
    v_perm_b32 v103, v190, v186, s93
    v_mfma_f32_16x16x32_bf16 v[44:47], v[96:99], v[140:143], 0
    v_mfma_f32_16x16x32_bf16 v[76:79], v[128:131], v[140:143], 0
    v_perm_b32 v108, v166, v162, s94
    v_perm_b32 v109, v174, v170, s94
    v_perm_b32 v110, v182, v178, s94
    v_perm_b32 v111, v190, v186, s94
    v_mfma_f32_16x16x32_bf16 v[48:51], v[96:99], v[100:103], 0
    v_mfma_f32_16x16x32_bf16 v[80:83], v[128:131], v[100:103], 0
    v_perm_b32 v132, v167, v163, s93
    v_perm_b32 v133, v175, v171, s93
    v_perm_b32 v134, v183, v179, s93
    v_perm_b32 v135, v191, v187, s93
    v_mfma_f32_16x16x32_bf16 v[52:55], v[96:99], v[108:111], 0
    v_mfma_f32_16x16x32_bf16 v[84:87], v[128:131], v[108:111], 0
    v_perm_b32 v140, v167, v163, s94
    v_perm_b32 v141, v175, v171, s94
    v_perm_b32 v142, v183, v179, s94
    v_perm_b32 v143, v191, v187, s94
    v_mfma_f32_16x16x32_bf16 v[56:59], v[96:99], v[132:135], 0
    v_mfma_f32_16x16x32_bf16 v[88:91], v[128:131], v[132:135], 0
    s_nop 0
    v_mfma_f32_16x16x32_bf16 v[60:63], v[96:99], v[140:143], 0
    v_mfma_f32_16x16x32_bf16 v[92:95], v[128:131], v[140:143], 0
    s_waitcnt vmcnt(8)
    v_perm_b32 v100, v196, v192, s93
    v_perm_b32 v101, v204, v200, s93
    v_perm_b32 v102, v212, v208, s93
    v_perm_b32 v103, v220, v216, s93
    v_perm_b32 v108, v196, v192, s94
    v_perm_b32 v109, v204, v200, s94
    v_perm_b32 v110, v212, v208, s94
    v_perm_b32 v111, v220, v216, s94
    v_mfma_f32_16x16x32_bf16 v[32:35], v[104:107], v[100:103], v[32:35]
    v_mfma_f32_16x16x32_bf16 v[64:67], v[136:139], v[100:103], v[64:67]
    v_perm_b32 v132, v197, v193, s93
    v_perm_b32 v133, v205, v201, s93
    v_perm_b32 v134, v213, v209, s93
    v_perm_b32 v135, v221, v217, s93
    v_mfma_f32_16x16x32_bf16 v[36:39], v[104:107], v[108:111], v[36:39]
    v_mfma_f32_16x16x32_bf16 v[68:71], v[136:139], v[108:111], v[68:71]
    v_perm_b32 v140, v197, v193, s94
    v_perm_b32 v141, v205, v201, s94
    v_perm_b32 v142, v213, v209, s94
    v_perm_b32 v143, v221, v217, s94
    v_mfma_f32_16x16x32_bf16 v[40:43], v[104:107], v[132:135], v[40:43]
    v_mfma_f32_16x16x32_bf16 v[72:75], v[136:139], v[132:135], v[72:75]
    v_perm_b32 v100, v198, v194, s93
    v_perm_b32 v101, v206, v202, s93
    v_perm_b32 v102, v214, v210, s93
    v_perm_b32 v103, v222, v218, s93
    v_mfma_f32_16x16x32_bf16 v[44:47], v[104:107], v[140:143], v[44:47]
    v_mfma_f32_16x16x32_bf16 v[76:79], v[136:139], v[140:143], v[76:79]
    v_perm_b32 v108, v198, v194, s94
    v_perm_b32 v109, v206, v202, s94
    v_perm_b32 v110, v214, v210, s94
    v_perm_b32 v111, v222, v218, s94
    v_mfma_f32_16x16x32_bf16 v[48:51], v[104:107], v[100:103], v[48:51]
    v_mfma_f32_16x16x32_bf16 v[80:83], v[136:139], v[100:103], v[80:83]
    v_perm_b32 v132, v199, v195, s93
    v_perm_b32 v133, v207, v203, s93
    v_perm_b32 v134, v215, v211, s93
    v_perm_b32 v135, v223, v219, s93
    v_mfma_f32_16x16x32_bf16 v[52:55], v[104:107], v[108:111], v[52:55]
    v_mfma_f32_16x16x32_bf16 v[84:87], v[136:139], v[108:111], v[84:87]
    v_perm_b32 v140, v199, v195, s94
    v_perm_b32 v141, v207, v203, s94
    v_perm_b32 v142, v215, v211, s94
    v_perm_b32 v143, v223, v219, s94
    v_mfma_f32_16x16x32_bf16 v[56:59], v[104:107], v[132:135], v[56:59]
    v_mfma_f32_16x16x32_bf16 v[88:91], v[136:139], v[132:135], v[88:91]
    s_nop 0
    v_mfma_f32_16x16x32_bf16 v[60:63], v[104:107], v[140:143], v[60:63]
    v_mfma_f32_16x16x32_bf16 v[92:95], v[136:139], v[140:143], v[92:95]
    s_cmp_lt_u32 s89, 4
    s_cbranch_scc1 L_S_nm
    s_and_b32 s90, s89, 3
    s_lshl_b32 s91, s90, 8
    s_add_u32 s91, s91, 131072
    v_lshl_add_u32 v6, v3, 3, s91
    s_lshl_b32 s90, s90, 14
    v_lshl_add_u32 v7, v1, 4, s90
    s_waitcnt lgkmcnt(0)
    s_barrier
    ds_read_b64 v[120:121], v6 offset:0
    ds_read_b64 v[152:153], v6 offset:128
    ds_read_b128 v[160:163], v7 offset:0
    ds_read_b128 v[164:167], v7 offset:1024
    ds_read_b128 v[168:171], v7 offset:2048
    ds_read_b128 v[172:175], v7 offset:3072
    ds_read_b128 v[176:179], v7 offset:4096
    ds_read_b128 v[180:183], v7 offset:5120
    ds_read_b128 v[184:187], v7 offset:6144
    ds_read_b128 v[188:191], v7 offset:7168
    ds_read_b128 v[192:195], v7 offset:8192
    ds_read_b128 v[196:199], v7 offset:9216
    ds_read_b128 v[200:203], v7 offset:10240
    ds_read_b128 v[204:207], v7 offset:11264
    ds_read_b128 v[208:211], v7 offset:12288
    ds_read_b128 v[212:215], v7 offset:13312
    ds_read_b128 v[216:219], v7 offset:14336
    ds_read_b128 v[220:223], v7 offset:15360
    s_waitcnt lgkmcnt(14)
    v_lshl_add_u32 v6, v3, 2, s91
    v_lshl_add_u32 v7, v2, 4, s91
    v_max_f32 v122, v20, v120
    v_sub_f32 v120, v120, v122
    v_sub_f32 v124, v20, v122
    v_mul_f32 v120, s92, v120
    v_mul_f32 v124, s92, v124
    v_exp_f32 v120, v120
    v_exp_f32 v124, v124
    v_mov_b32 v20, v122
    v_mul_f32 v21, v21, v124
    v_fmac_f32 v21, v120, v121
    ds_write_b32 v6, v120 offset:1024
    ds_write_b32 v6, v124 offset:1088
    v_max_f32 v154, v22, v152
    v_sub_f32 v152, v152, v154
    v_sub_f32 v156, v22, v154
    v_mul_f32 v152, s92, v152
    v_mul_f32 v156, s92, v156
    v_exp_f32 v152, v152
    v_exp_f32 v156, v156
    v_mov_b32 v22, v154
    v_mul_f32 v23, v23, v156
    v_fmac_f32 v23, v152, v153
    ds_write_b32 v6, v152 offset:1152
    ds_write_b32 v6, v156 offset:1216
    s_waitcnt lgkmcnt(0)
    ds_read_b128 v[120:123], v7 offset:1024
    ds_read_b128 v[124:127], v7 offset:1088
    ds_read_b128 v[152:155], v7 offset:1152
    ds_read_b128 v[156:159], v7 offset:1216
    s_waitcnt lgkmcnt(0)
    v_mul_f32 v160, v160, v120
    v_mul_f32 v161, v161, v121
    v_mul_f32 v162, v162, v122
    v_mul_f32 v163, v163, v123
    v_mul_f32 v164, v164, v120
    v_mul_f32 v165, v165, v121
    v_mul_f32 v166, v166, v122
    v_mul_f32 v167, v167, v123
    v_mul_f32 v168, v168, v120
    v_mul_f32 v169, v169, v121
    v_mul_f32 v170, v170, v122
    v_mul_f32 v171, v171, v123
    v_mul_f32 v172, v172, v120
    v_mul_f32 v173, v173, v121
    v_mul_f32 v174, v174, v122
    v_mul_f32 v175, v175, v123
    v_mul_f32 v176, v176, v120
    v_mul_f32 v177, v177, v121
    v_mul_f32 v178, v178, v122
    v_mul_f32 v179, v179, v123
    v_mul_f32 v180, v180, v120
    v_mul_f32 v181, v181, v121
    v_mul_f32 v182, v182, v122
    v_mul_f32 v183, v183, v123
    v_mul_f32 v184, v184, v120
    v_mul_f32 v185, v185, v121
    v_mul_f32 v186, v186, v122
    v_mul_f32 v187, v187, v123
    v_mul_f32 v188, v188, v120
    v_mul_f32 v189, v189, v121
    v_mul_f32 v190, v190, v122
    v_mul_f32 v191, v191, v123
    v_mul_f32 v192, v192, v152
    v_mul_f32 v193, v193, v153
    v_mul_f32 v194, v194, v154
    v_mul_f32 v195, v195, v155
    v_mul_f32 v196, v196, v152
    v_mul_f32 v197, v197, v153
    v_mul_f32 v198, v198, v154
    v_mul_f32 v199, v199, v155
    v_mul_f32 v200, v200, v152
    v_mul_f32 v201, v201, v153
    v_mul_f32 v202, v202, v154
    v_mul_f32 v203, v203, v155
    v_mul_f32 v204, v204, v152
    v_mul_f32 v205, v205, v153
    v_mul_f32 v206, v206, v154
    v_mul_f32 v207, v207, v155
    v_mul_f32 v208, v208, v152
    v_mul_f32 v209, v209, v153
    v_mul_f32 v210, v210, v154
    v_mul_f32 v211, v211, v155
    v_mul_f32 v212, v212, v152
    v_mul_f32 v213, v213, v153
    v_mul_f32 v214, v214, v154
    v_mul_f32 v215, v215, v155
    v_mul_f32 v216, v216, v152
    v_mul_f32 v217, v217, v153
    v_mul_f32 v218, v218, v154
    v_mul_f32 v219, v219, v155
    v_mul_f32 v220, v220, v152
    v_mul_f32 v221, v221, v153
    v_mul_f32 v222, v222, v154
    v_mul_f32 v223, v223, v155
L_S_nm:
    s_waitcnt vmcnt(0)
    v_perm_b32 v100, v228, v224, s93
    v_perm_b32 v101, v236, v232, s93
    v_perm_b32 v102, v244, v240, s93
    v_perm_b32 v103, v252, v248, s93
    v_perm_b32 v108, v228, v224, s94
    v_perm_b32 v109, v236, v232, s94
    v_perm_b32 v110, v244, v240, s94
    v_perm_b32 v111, v252, v248, s94
    v_mfma_f32_16x16x32_bf16 v[32:35], v[112:115], v[100:103], v[32:35]
    v_mfma_f32_16x16x32_bf16 v[64:67], v[144:147], v[100:103], v[64:67]
    v_perm_b32 v132, v229, v225, s93
    v_perm_b32 v133, v237, v233, s93
    v_perm_b32 v134, v245, v241, s93
    v_perm_b32 v135, v253, v249, s93
    v_mfma_f32_16x16x32_bf16 v[36:39], v[112:115], v[108:111], v[36:39]
    v_mfma_f32_16x16x32_bf16 v[68:71], v[144:147], v[108:111], v[68:71]
    v_perm_b32 v140, v229, v225, s94
    v_perm_b32 v141, v237, v233, s94
    v_perm_b32 v142, v245, v241, s94
    v_perm_b32 v143, v253, v249, s94
    v_mfma_f32_16x16x32_bf16 v[40:43], v[112:115], v[132:135], v[40:43]
    v_mfma_f32_16x16x32_bf16 v[72:75], v[144:147], v[132:135], v[72:75]
    v_perm_b32 v100, v230, v226, s93
    v_perm_b32 v101, v238, v234, s93
    v_perm_b32 v102, v246, v242, s93
    v_perm_b32 v103, v254, v250, s93
    v_mfma_f32_16x16x32_bf16 v[44:47], v[112:115], v[140:143], v[44:47]
    v_mfma_f32_16x16x32_bf16 v[76:79], v[144:147], v[140:143], v[76:79]
    v_perm_b32 v108, v230, v226, s94
    v_perm_b32 v109, v238, v234, s94
    v_perm_b32 v110, v246, v242, s94
    v_perm_b32 v111, v254, v250, s94
    v_mfma_f32_16x16x32_bf16 v[48:51], v[112:115], v[100:103], v[48:51]
    v_mfma_f32_16x16x32_bf16 v[80:83], v[144:147], v[100:103], v[80:83]
    v_perm_b32 v132, v231, v227, s93
    v_perm_b32 v133, v239, v235, s93
    v_perm_b32 v134, v247, v243, s93
    v_perm_b32 v135, v255, v251, s93
    v_mfma_f32_16x16x32_bf16 v[52:55], v[112:115], v[108:111], v[52:55]
    v_mfma_f32_16x16x32_bf16 v[84:87], v[144:147], v[108:111], v[84:87]
    v_perm_b32 v140, v231, v227, s94
    v_perm_b32 v141, v239, v235, s94
    v_perm_b32 v142, v247, v243, s94
    v_perm_b32 v143, v255, v251, s94
    v_mfma_f32_16x16x32_bf16 v[56:59], v[112:115], v[132:135], v[56:59]
    v_mfma_f32_16x16x32_bf16 v[88:91], v[144:147], v[132:135], v[88:91]
    s_nop 0
    v_mfma_f32_16x16x32_bf16 v[60:63], v[112:115], v[140:143], v[60:63]
    v_mfma_f32_16x16x32_bf16 v[92:95], v[144:147], v[140:143], v[92:95]
    s_cmp_ge_u32 s89, 4
    s_cbranch_scc1 L_S_fin
    s_lshl_b32 s91, s89, 8
    s_add_u32 s91, s91, 131072
    v_lshl_add_u32 v6, v3, 3, s91
    v_lshl_add_u32 v7, v1, 4, s96
    s_nop 3
    ds_write_b64 v6, v[20:21] offset:0
    ds_write_b64 v6, v[22:23] offset:128
    ds_write_b128 v7, v[32:35] offset:0
    ds_write_b128 v7, v[36:39] offset:1024
    ds_write_b128 v7, v[40:43] offset:2048
    ds_write_b128 v7, v[44:47] offset:3072
    ds_write_b128 v7, v[48:51] offset:4096
    ds_write_b128 v7, v[52:55] offset:5120
    ds_write_b128 v7, v[56:59] offset:6144
    ds_write_b128 v7, v[60:63] offset:7168
    ds_write_b128 v7, v[64:67] offset:8192
    ds_write_b128 v7, v[68:71] offset:9216
    ds_write_b128 v7, v[72:75] offset:10240
    ds_write_b128 v7, v[76:79] offset:11264
    ds_write_b128 v7, v[80:83] offset:12288
    ds_write_b128 v7, v[84:87] offset:13312
    ds_write_b128 v7, v[88:91] offset:14336
    ds_write_b128 v7, v[92:95] offset:15360
    s_waitcnt lgkmcnt(0)
    s_barrier
    s_branch L_S_more
L_S_fin:
    s_nop 5
    v_fma_f32 v32, v32, v124, v160
    v_fma_f32 v33, v33, v125, v161
    v_fma_f32 v34, v34, v126, v162
    v_fma_f32 v35, v35, v127, v163
    v_fma_f32 v36, v36, v124, v164
    v_fma_f32 v37, v37, v125, v165
    v_fma_f32 v38, v38, v126, v166
    v_fma_f32 v39, v39, v127, v167
    v_fma_f32 v40, v40, v124, v168
    v_fma_f32 v41, v41, v125, v169
    v_fma_f32 v42, v42, v126, v170
    v_fma_f32 v43, v43, v127, v171
    v_fma_f32 v44, v44, v124, v172
    v_fma_f32 v45, v45, v125, v173
    v_fma_f32 v46, v46, v126, v174
    v_fma_f32 v47, v47, v127, v175
    v_fma_f32 v48, v48, v124, v176
    v_fma_f32 v49, v49, v125, v177
    v_fma_f32 v50, v50, v126, v178
    v_fma_f32 v51, v51, v127, v179
    v_fma_f32 v52, v52, v124, v180
    v_fma_f32 v53, v53, v125, v181
    v_fma_f32 v54, v54, v126, v182
    v_fma_f32 v55, v55, v127, v183
    v_fma_f32 v56, v56, v124, v184
    v_fma_f32 v57, v57, v125, v185
    v_fma_f32 v58, v58, v126, v186
    v_fma_f32 v59, v59, v127, v187
    v_fma_f32 v60, v60, v124, v188
    v_fma_f32 v61, v61, v125, v189
    v_fma_f32 v62, v62, v126, v190
    v_fma_f32 v63, v63, v127, v191
    v_fma_f32 v64, v64, v156, v192
    v_fma_f32 v65, v65, v157, v193
    v_fma_f32 v66, v66, v158, v194
    v_fma_f32 v67, v67, v159, v195
    v_fma_f32 v68, v68, v156, v196
    v_fma_f32 v69, v69, v157, v197
    v_fma_f32 v70, v70, v158, v198
    v_fma_f32 v71, v71, v159, v199
    v_fma_f32 v72, v72, v156, v200
    v_fma_f32 v73, v73, v157, v201
    v_fma_f32 v74, v74, v158, v202
    v_fma_f32 v75, v75, v159, v203
    v_fma_f32 v76, v76, v156, v204
    v_fma_f32 v77, v77, v157, v205
    v_fma_f32 v78, v78, v158, v206
    v_fma_f32 v79, v79, v159, v207
    v_fma_f32 v80, v80, v156, v208
    v_fma_f32 v81, v81, v157, v209
    v_fma_f32 v82, v82, v158, v210
    v_fma_f32 v83, v83, v159, v211
    v_fma_f32 v84, v84, v156, v212
    v_fma_f32 v85, v85, v157, v213
    v_fma_f32 v86, v86, v158, v214
    v_fma_f32 v87, v87, v159, v215
    v_fma_f32 v88, v88, v156, v216
    v_fma_f32 v89, v89, v157, v217
    v_fma_f32 v90, v90, v158, v218
    v_fma_f32 v91, v91, v159, v219
    v_fma_f32 v92, v92, v156, v220
    v_fma_f32 v93, v93, v157, v221
    v_fma_f32 v94, v94, v158, v222
    v_fma_f32 v95, v95, v159, v223
    s_mov_b32 exec_lo, s78
    s_mov_b32 exec_hi, 0
    buffer_store_dwordx2 v[20:21], v25, s[32:35], s81 offen sc1
    buffer_store_dwordx2 v[22:23], v25, s[32:35], s82 offen sc1
    s_mov_b64 exec, -1
    s_mov_b64 exec, s[76:77]
    v_cvt_pk_bf16_f32 v224, v32, v36
    v_cvt_pk_bf16_f32 v225, v40, v44
    v_cvt_pk_bf16_f32 v226, v48, v52
    v_cvt_pk_bf16_f32 v227, v56, v60
    s_add_u32 s90, s80, 0
    s_bitcmp1_b32 s79, 0
    s_cselect_b32 s90, s90, s95
    buffer_store_dwordx4 v[224:227], v24, s[32:35], s90 offen sc1
    v_cvt_pk_bf16_f32 v228, v33, v37
    v_cvt_pk_bf16_f32 v229, v41, v45
    v_cvt_pk_bf16_f32 v230, v49, v53
    v_cvt_pk_bf16_f32 v231, v57, v61
    s_add_u32 s90, s80, 12288
    s_bitcmp1_b32 s79, 0
    s_cselect_b32 s90, s90, s95
    buffer_store_dwordx4 v[228:231], v24, s[32:35], s90 offen sc1
    v_cvt_pk_bf16_f32 v232, v34, v38
    v_cvt_pk_bf16_f32 v233, v42, v46
    v_cvt_pk_bf16_f32 v234, v50, v54
    v_cvt_pk_bf16_f32 v235, v58, v62
    s_add_u32 s90, s80, 24576
    s_bitcmp1_b32 s79, 0
    s_cselect_b32 s90, s90, s95
    buffer_store_dwordx4 v[232:235], v24, s[32:35], s90 offen sc1
    v_cvt_pk_bf16_f32 v236, v35, v39
    v_cvt_pk_bf16_f32 v237, v43, v47
    v_cvt_pk_bf16_f32 v238, v51, v55
    v_cvt_pk_bf16_f32 v239, v59, v63
    s_add_u32 s90, s80, 36864
    s_bitcmp1_b32 s79, 0
    s_cselect_b32 s90, s90, s95
    buffer_store_dwordx4 v[236:239], v24, s[32:35], s90 offen sc1
    v_cvt_pk_bf16_f32 v240, v64, v68
    v_cvt_pk_bf16_f32 v241, v72, v76
    v_cvt_pk_bf16_f32 v242, v80, v84
    v_cvt_pk_bf16_f32 v243, v88, v92
    s_add_u32 s90, s80, 1572864
    s_bitcmp1_b32 s79, 1
    s_cselect_b32 s90, s90, s95
    buffer_store_dwordx4 v[240:243], v24, s[32:35], s90 offen sc1
    v_cvt_pk_bf16_f32 v244, v65, v69
    v_cvt_pk_bf16_f32 v245, v73, v77
    v_cvt_pk_bf16_f32 v246, v81, v85
    v_cvt_pk_bf16_f32 v247, v89, v93
    s_add_u32 s90, s80, 1585152
    s_bitcmp1_b32 s79, 1
    s_cselect_b32 s90, s90, s95
    buffer_store_dwordx4 v[244:247], v24, s[32:35], s90 offen sc1
    v_cvt_pk_bf16_f32 v248, v66, v70
    v_cvt_pk_bf16_f32 v249, v74, v78
    v_cvt_pk_bf16_f32 v250, v82, v86
    v_cvt_pk_bf16_f32 v251, v90, v94
    s_add_u32 s90, s80, 1597440
    s_bitcmp1_b32 s79, 1
    s_cselect_b32 s90, s90, s95
    buffer_store_dwordx4 v[248:251], v24, s[32:35], s90 offen sc1
    v_cvt_pk_bf16_f32 v252, v67, v71
    v_cvt_pk_bf16_f32 v253, v75, v79
    v_cvt_pk_bf16_f32 v254, v83, v87
    v_cvt_pk_bf16_f32 v255, v91, v95
    s_add_u32 s90, s80, 1609728
    s_bitcmp1_b32 s79, 1
    s_cselect_b32 s90, s90, s95
    buffer_store_dwordx4 v[252:255], v24, s[32:35], s90 offen sc1
    s_mov_b64 exec, -1
L_S_more:
    s_cmp_lg_u32 s51, 0
    s_cbranch_scc1 L_done
    s_add_u32 s84, s84, 1
    s_cmp_ge_u32 s84, 8
    s_cbranch_scc1 L_done
    s_waitcnt vmcnt(0)
    s_barrier
    s_lshl_b32 s90, s84, 11
    s_lshr_b32 s91, s86, 4
    s_lshl_b32 s91, s91, 2
    s_add_u32 s90, s90, s91
    s_add_u32 s91, s90, 32
    s_buffer_load_dwordx8 s[68:75], s[36:39], s90
    s_buffer_load_dword s76, s[36:39], s91
    s_mov_b32 s49, 1
    s_branch L_S_iter
L_done:
    s_cmp_lg_u32 s89, 0
    s_cbranch_scc1 L_nopf
    s_getpc_b64 s[60:61]
L_pc:
    s_add_u32 s60, s60, combine_kernel-L_pc
    s_addc_u32 s61, s61, 0
    v_lshlrev_b32 v24, 5, v1
    v_min_u32 v24, L_code_end-combine_kernel-4, v24
    global_load_dword v25, v24, s[60:61]
L_nopf:
L_end:
    s_endpgm
.globl combine_kernel
.p2align 8
.type combine_kernel,@function
combine_kernel:
    s_cmp_ge_u32 s2, 256
    s_cbranch_scc1 L_cend
    s_load_dwordx8 s[4:11], s[0:1], 32
    v_lshrrev_b32 v1, 6, v0
    v_and_b32 v0, 63, v0
    v_readfirstlane_b32 s3, v1
    s_lshl_b32 s2, s2, 2
    v_lshrrev_b32 v1, 2, v0
    v_and_b32 v2, 3, v0
    s_add_u32 s2, s2, s3
    s_and_b32 s3, s2, 3
    s_lshr_b32 s2, s2, 2
    v_lshlrev_b32 v3, 8, v1
    v_lshl_add_u32 v3, v2, 4, v3
    s_mul_i32 s26, s2, 12288
    s_lshl_b32 s3, s3, 6
    s_add_u32 s26, s26, s3
    s_lshr_b32 s24, s2, 5
    s_lshl_b32 s25, s24, 2
    s_bfe_u32 s22, s2, 0x30002
    s_and_b32 s23, s2, 3
    s_mul_i32 s27, s22, 5632
    s_add_u32 s28, s25, s23
    s_lshl_b32 s28, s28, 3
    s_add_u32 s27, s27, s28
    s_add_u32 s27, s27, 3145728
    s_lshr_b32 s28, s2, 2
    s_mul_i32 s28, s28, 3328
    s_lshl_b32 s30, s23, 5
    s_add_u32 s28, s28, s30
    s_add_u32 s28, s28, 3190016
    v_lshl_add_u32 v4, v1, 8, s27
    v_lshl_add_u32 v5, v1, 7, s28
    s_mov_b32 s36, 0x5ef940f
    s_cmp_eq_u32 s24, 1
    s_cselect_b32 s36, 0x9f7280d, s36
    s_cmp_eq_u32 s24, 2
    s_cselect_b32 s36, 0x11d6bc0c, s36
    s_cmp_eq_u32 s24, 3
    s_cselect_b32 s36, 0x5de4f0a, s36
    s_cmp_eq_u32 s24, 4
    s_cselect_b32 s36, 0x25d7e311, s36
    s_cmp_eq_u32 s24, 5
    s_cselect_b32 s36, 0x9df770f, s36
    s_cmp_eq_u32 s24, 6
    s_cselect_b32 s36, 0x31df0b0d, s36
    s_cmp_eq_u32 s24, 7
    s_cselect_b32 s36, 0x29e69e0b, s36
    s_and_b32 s46, s36, 255
    s_add_u32 s46, s46, 22
    v_add_u32 v6, 4096, v4
    v_cmp_gt_u32 vcc, 6, v1
    s_mov_b32 s14, 301989888
    s_mov_b32 s15, 0x20000
    v_cndmask_b32 v6, v5, v6, vcc
    s_add_u32 s29, s26, 4096
    s_add_u32 s30, s26, 8192
    s_mov_b32 s47, 0x80000000
    s_sub_u32 s31, s46, 33
    v_sub_u32 v7, s31, v1
    v_and_or_b32 v22, v7, s47, v5
    v_and_or_b32 v23, v7, s47, v3
    s_waitcnt lgkmcnt(0)
    s_mov_b32 s12, s10
    s_mov_b32 s13, s11
    s_load_dword s21, s[4:5], s25
    buffer_load_dwordx2 v[8:9], v4, s[12:15], 0 offen offset:0
    buffer_load_dwordx2 v[10:11], v6, s[12:15], 0 offen offset:0
    buffer_load_dwordx2 v[12:13], v22, s[12:15], 0 offen offset:2048
    buffer_load_dwordx4 v[32:35], v3, s[12:15], s26 offen
    buffer_load_dwordx4 v[36:39], v3, s[12:15], s29 offen
    buffer_load_dwordx4 v[40:43], v23, s[12:15], s30 offen
    s_mov_b32 s16, s6
    s_mov_b32 s17, s7
    s_mov_b32 s18, 65536
    s_mov_b32 s19, 0x20000
    s_lshl_b32 s32, s2, 8
    s_add_u32 s32, s32, s3
    s_mov_b32 s33, 0x3e0293ee
    s_mov_b32 s34, 0xffff0000
    v_mov_b32 v16, 0xff7fffff
    s_bfe_u32 s37, s36, 0xb0008
    s_bfe_u32 s35, s36, 0x70013
    s_lshr_b32 s38, s36, 26
    s_and_b32 s36, s36, 255
    v_mul_u32_u24 v18, s35, v0
    v_min_u32 v19, s38, v0
    v_add_u32 v18, v18, v19
    v_add_u32 v18, 1024, v18
    v_subrev_u32 v19, s36, v0
    v_lshlrev_b32 v19, 6, v19
    v_add_u32 v19, s37, v19
    v_cmp_gt_u32 vcc, s36, v0
    v_lshrrev_b32 v20, 4, v0
    v_lshlrev_b32 v20, 2, v20
    v_lshl_add_u32 v20, v2, 4, v20
    v_cndmask_b32 v18, v19, v18, vcc
    s_waitcnt lgkmcnt(0)
    s_sub_u32 s21, s21, 1
    s_min_u32 s21, s21, 8191
    s_lshr_b32 s21, s21, 2
    v_cmp_ge_u32 vcc, s21, v18
    s_bcnt1_i32_b64 s21, vcc
    s_add_u32 s21, s21, 22
    v_sub_u32 v17, s21, v1
    s_cmp_le_u32 s21, s46
    s_cbranch_scc1 L_cok
    s_waitcnt vmcnt(0)
    buffer_load_dwordx2 v[12:13], v5, s[12:15], 0 offen offset:2048
    buffer_load_dwordx4 v[40:43], v3, s[12:15], s30 offen
    s_waitcnt vmcnt(0)
L_cok:
    v_cmp_lt_i32 s[42:43], 16, v17
    v_cmp_lt_i32 s[44:45], 32, v17
    s_waitcnt vmcnt(3)
    v_cndmask_b32 v10, v16, v10, s[42:43]
    v_cndmask_b32 v11, 0, v11, s[42:43]
    v_cndmask_b32 v12, v16, v12, s[44:45]
    v_cndmask_b32 v13, 0, v13, s[44:45]
    v_max3_f32 v16, v8, v10, v12
    s_nop 1
    v_max_f32_dpp v16, v16, v16 row_ror:8 row_mask:0xf bank_mask:0xf
    s_nop 1
    v_max_f32_dpp v16, v16, v16 row_ror:4 row_mask:0xf bank_mask:0xf
    v_mov_b32 v18, v16
    s_nop 1
    v_permlane16_swap_b32 v18, v16
    v_max_f32 v16, v16, v18
    v_mov_b32 v18, v16
    s_nop 1
    v_permlane32_swap_b32 v18, v16
    v_max_f32 v16, v16, v18
    v_sub_f32 v8, v8, v16
    v_sub_f32 v10, v10, v16
    v_sub_f32 v12, v12, v16
    v_mul_f32 v8, s33, v8
    v_mul_f32 v10, s33, v10
    v_mul_f32 v12, s33, v12
    v_exp_f32 v8, v8
    v_exp_f32 v10, v10
    v_exp_f32 v12, v12
    s_waitcnt vmcnt(2)
    v_lshlrev_b32 v48, 16, v32
    v_and_b32 v52, s34, v32
    v_lshlrev_b32 v49, 16, v33
    v_and_b32 v53, s34, v33
    v_lshlrev_b32 v50, 16, v34
    v_and_b32 v54, s34, v34
    v_lshlrev_b32 v51, 16, v35
    v_and_b32 v55, s34, v35
    v_mul_f32 v24, v8, v48
    v_mul_f32 v25, v8, v52
    v_mul_f32 v26, v8, v49
    v_mul_f32 v27, v8, v53
    v_mul_f32 v28, v8, v50
    v_mul_f32 v29, v8, v54
    v_mul_f32 v30, v8, v51
    v_mul_f32 v31, v8, v55
    v_mul_f32 v21, v8, v9
    s_waitcnt vmcnt(1)
    v_cndmask_b32 v36, 0, v36, s[42:43]
    v_cndmask_b32 v37, 0, v37, s[42:43]
    v_cndmask_b32 v38, 0, v38, s[42:43]
    v_cndmask_b32 v39, 0, v39, s[42:43]
    v_lshlrev_b32 v48, 16, v36
    v_and_b32 v52, s34, v36
    v_lshlrev_b32 v49, 16, v37
    v_and_b32 v53, s34, v37
    v_lshlrev_b32 v50, 16, v38
    v_and_b32 v54, s34, v38
    v_lshlrev_b32 v51, 16, v39
    v_and_b32 v55, s34, v39
    v_fmac_f32 v24, v10, v48
    v_fmac_f32 v25, v10, v52
    v_fmac_f32 v26, v10, v49
    v_fmac_f32 v27, v10, v53
    v_fmac_f32 v28, v10, v50
    v_fmac_f32 v29, v10, v54
    v_fmac_f32 v30, v10, v51
    v_fmac_f32 v31, v10, v55
    v_fmac_f32 v21, v10, v11
    s_waitcnt vmcnt(0)
    v_cndmask_b32 v40, 0, v40, s[44:45]
    v_cndmask_b32 v41, 0, v41, s[44:45]
    v_cndmask_b32 v42, 0, v42, s[44:45]
    v_cndmask_b32 v43, 0, v43, s[44:45]
    v_lshlrev_b32 v48, 16, v40
    v_and_b32 v52, s34, v40
    v_lshlrev_b32 v49, 16, v41
    v_and_b32 v53, s34, v41
    v_lshlrev_b32 v50, 16, v42
    v_and_b32 v54, s34, v42
    v_lshlrev_b32 v51, 16, v43
    v_and_b32 v55, s34, v43
    v_fmac_f32 v24, v12, v48
    v_fmac_f32 v25, v12, v52
    v_fmac_f32 v26, v12, v49
    v_fmac_f32 v27, v12, v53
    v_fmac_f32 v28, v12, v50
    v_fmac_f32 v29, v12, v54
    v_fmac_f32 v30, v12, v51
    v_fmac_f32 v31, v12, v55
    v_fmac_f32 v21, v12, v13
    v_mov_b32 v22, v21
    s_nop 0
    v_permlane32_swap_b32 v24, v28
    v_permlane32_swap_b32 v25, v29
    v_permlane32_swap_b32 v26, v30
    v_permlane32_swap_b32 v27, v31
    v_permlane32_swap_b32 v21, v22
    v_add_f32 v24, v24, v28
    v_add_f32 v25, v25, v29
    v_add_f32 v26, v26, v30
    v_add_f32 v27, v27, v31
    v_add_f32 v21, v21, v22
    v_mov_b32 v22, v21
    s_nop 0
    v_permlane16_swap_b32 v24, v26
    v_permlane16_swap_b32 v25, v27
    v_permlane16_swap_b32 v21, v22
    v_add_f32 v24, v24, v26
    v_add_f32 v25, v25, v27
    v_add_f32 v21, v21, v22
    s_nop 0
    v_add_f32_dpp v24, v24, v24 row_ror:8 row_mask:0xf bank_mask:0xf
    v_add_f32_dpp v25, v25, v25 row_ror:8 row_mask:0xf bank_mask:0xf
    v_add_f32_dpp v21, v21, v21 row_ror:8 row_mask:0xf bank_mask:0xf
    s_nop 0
    v_add_f32_dpp v24, v24, v24 row_ror:4 row_mask:0xf bank_mask:0xf
    v_add_f32_dpp v25, v25, v25 row_ror:4 row_mask:0xf bank_mask:0xf
    v_add_f32_dpp v21, v21, v21 row_ror:4 row_mask:0xf bank_mask:0xf
    v_rcp_f32 v21, v21
    s_mov_b32 exec_lo, 0x000f000f
    s_mov_b32 exec_hi, 0x000f000f
    v_mul_f32 v24, v24, v21
    v_mul_f32 v25, v25, v21
    v_cvt_pk_bf16_f32 v24, v24, v25
    buffer_store_dword v24, v20, s[16:19], s32 offen
L_cend:
    s_endpgm
L_code_end:
.section .rodata,"a"
.p2align 6
.amdhsa_kernel standalone__paged_block_table_kv_radixattention__decode_kernel
  .amdhsa_next_free_vgpr 256
  .amdhsa_next_free_sgpr 102
  .amdhsa_accum_offset 256
  .amdhsa_group_segment_fixed_size 0
  .amdhsa_kernarg_size 64
  .amdhsa_user_sgpr_count 2
  .amdhsa_user_sgpr_kernarg_segment_ptr 1
  .amdhsa_system_sgpr_workgroup_id_x 1
.end_amdhsa_kernel
.section .rodata,"a"
.p2align 6
.amdhsa_kernel combine_kernel
  .amdhsa_next_free_vgpr 56
  .amdhsa_next_free_sgpr 48
  .amdhsa_accum_offset 56
  .amdhsa_group_segment_fixed_size 0
  .amdhsa_kernarg_size 64
  .amdhsa_user_sgpr_count 2
  .amdhsa_user_sgpr_kernarg_segment_ptr 1
  .amdhsa_system_sgpr_workgroup_id_x 1
.end_amdhsa_kernel
```
